```python
import torch

def _softmax(x, axis=-1):
    return torch.softmax(x, dim=axis)
def _gelu(x):
    return torch.nn.functional.gelu(x, approximate="tanh")
def _silu(x):
    return torch.nn.functional.silu(x)
def _sigmoid(x):
    return torch.sigmoid(x)
def _layernorm(x, axis=-1, eps=1e-5):
    m = x.mean(dim=axis, keepdim=True)
    v = x.var(dim=axis, keepdim=True, unbiased=False)
    return (x - m) / torch.sqrt(v + eps)
def _scatter_add(tgt, idx, src, axis=0):
    return tgt.clone().index_add_(axis, idx, src)
def _segment_sum(src, seg, n):
    out = torch.zeros((n,) + src.shape[1:], dtype=src.dtype)
    return out.index_add_(0, seg, src)
def _pad(x, pw):
    flat = tuple(v for pair in reversed(pw) for v in pair)
    return torch.nn.functional.pad(x, flat)

kernel_name = 'gated_mix__gqa_block_cached__geglu_ffn__decode'

def setup_inputs():

    _w = (lambda a: (lambda t: t.to(torch.bfloat16) if t.is_floating_point() else t)(torch.as_tensor(a)))
    def _A_setup():
        B, Sq, D = 2, 1, 640
        Hq, Hkv, Sk, Dh = 32, 32, 8192, 128
        assert Hq % Hkv == 0, (Hq, Hkv)
        return {
            "x": _w((lambda *s: torch.randn(*s, dtype=torch.bfloat16) * 0.05)(B, Sq, D)),
            "k_cache": _w((lambda *s: torch.randn(*s, dtype=torch.bfloat16) * 6.4)(B, Hkv, Sk, Dh)),
            "v_cache": _w((lambda *s: torch.randn(*s, dtype=torch.bfloat16) * 0.2)(B, Hkv, Sk, Dh)),
            "wq": _w((lambda *s: torch.randn(*s, dtype=torch.bfloat16) * 6.4)(D, Hq * Dh) * (D ** -0.5)),
            "wo": _w((lambda *s: torch.randn(*s, dtype=torch.bfloat16) * 0.2)(Hq * Dh, D) * ((Hq * Dh) ** -0.5)),
        }
    _A_in = _A_setup()

    def _B_setup():
        B, S, D, F = 2, 1, 640, 1728
        return {
            "x": _w((lambda *s: torch.randn(*s, dtype=torch.bfloat16) * 0.05)(B, S, D)),
            "w_gate": _w((lambda *s: torch.randn(*s, dtype=torch.bfloat16) * 0.05)(D, F)),
            "w_up": _w((lambda *s: torch.randn(*s, dtype=torch.bfloat16) * 0.05)(D, F)),
            "w_down": _w((lambda *s: torch.randn(*s, dtype=torch.bfloat16) * 0.05)(F, D)),
        }
    _B_in = _B_setup()

    return {
        "A_x": _A_in["x"],
        "A_k_cache": _A_in["k_cache"],
        "A_v_cache": _A_in["v_cache"],
        "A_wq": _A_in["wq"],
        "A_wo": _A_in["wo"],
        "B_x": _B_in["x"],
        "B_w_gate": _B_in["w_gate"],
        "B_w_up": _B_in["w_up"],
        "B_w_down": _B_in["w_down"],
        "gate_w": _w((lambda *s: torch.randn(*s, dtype=torch.bfloat16) * 0.05)(640) * 16.0),
    }

def reference(A_x, A_k_cache, A_v_cache, A_wq, A_wo, B_x, B_w_gate, B_w_up, B_w_down, gate_w):
    def _A_ref(x, k_cache, v_cache, wq, wo):
        B, Sq, D = x.shape
        Hq, Dh = 32, 128
        Hkv = k_cache.shape[1]
        rep = Hq // Hkv
        q = (lambda x, *d: x.permute(*d))((x @ wq).reshape(B, Sq, Hq, Dh), 0, 2, 1, 3)
        k = (lambda x, n, axis: torch.repeat_interleave(x, n, dim=axis))(k_cache, rep, axis=1)
        v = (lambda x, n, axis: torch.repeat_interleave(x, n, dim=axis))(v_cache, rep, axis=1)
        scores = torch.einsum("bhqd,bhkd->bhqk", q, k) * (Dh ** -0.5)
        p = _softmax(scores, axis=-1)
        o = torch.einsum("bhqk,bhkd->bhqd", p, v)
        return (lambda x, *d: x.permute(*d))(o, 0, 2, 1, 3).reshape(B, Sq, Hq * Dh) @ wo

    def _B_ref(x, w_gate, w_up, w_down):
        return (_gelu(x @ w_gate) * (x @ w_up)) @ w_down

    x = A_x
    g = _sigmoid((x * gate_w).sum(-1, keepdims=True))
    a = _A_ref(x, A_k_cache, A_v_cache, A_wq, A_wo)
    b = _B_ref(x, B_w_gate, B_w_up, B_w_down)
    return g * a + (1 - g) * b
```

```asm
; @launch grid=(256,1,1) block=(256,1,1) lds=16384
.amdgcn_target "amdgcn-amd-amdhsa--gfx950"
.text
.globl gated_mix__gqa_block_cached__geglu_ffn__decode_kernel
.p2align 8
.type gated_mix__gqa_block_cached__geglu_ffn__decode_kernel,@function
gated_mix__gqa_block_cached__geglu_ffn__decode_kernel:
  s_cmp_ge_u32 s2, 256
  s_cbranch_scc1 L_end
  s_load_dwordx8 s[64:71], s[0:1], 0
  v_lshrrev_b32 v4, 6, v0
  v_and_b32 v0, 63, v0
  v_readfirstlane_b32 s3, v4
  s_and_b32 s8, s2, 7
  s_lshr_b32 s9, s2, 6
  s_lshl_b32 s8, s8, 2
  s_add_u32 s4, s8, s9
  s_bfe_u32 s21, s2, 0x30003
  s_lshr_b32 s5, s21, 2
  v_lshrrev_b32 v2, 4, v0
  v_and_b32 v3, 15, v0
  s_mov_b32 s54, 5242880
  s_mov_b32 s55, 0x20000
  s_mov_b32 s62, 2560
  s_mov_b32 s63, 0x20000
  s_sub_u32 s8, s21, 5
  s_cmp_ge_u32 s21, 5
  s_cselect_b32 s16, s8, s21
  s_lshl_b32 s8, s3, 18
  s_lshl_b32 s9, s4, 8
  s_add_u32 s8, s8, s9
  v_lshlrev_b32 v95, 16, v2
  v_lshl_add_u32 v95, v3, 4, v95
  v_add_u32 v95, s8, v95
  s_movk_i32 s22, 8192
  s_lshl_b32 s95, s16, 20
  s_add_u32 s17, s16, 1
  s_cmp_eq_u32 s17, 5
  s_cselect_b32 s17, 0, s17
  s_add_u32 s18, s17, 1
  s_cmp_eq_u32 s18, 5
  s_cselect_b32 s18, 0, s18
  s_add_u32 s19, s18, 1
  s_cmp_eq_u32 s19, 5
  s_cselect_b32 s19, 0, s19
  s_add_u32 s20, s19, 1
  s_cmp_eq_u32 s20, 5
  s_cselect_b32 s20, 0, s20
  s_mul_i32 s8, s5, 1280
  s_lshl_b32 s9, s3, 6
  s_add_u32 s8, s8, s9
  v_lshlrev_b32 v94, 4, v2
  v_add_u32 v94, s8, v94
  s_waitcnt lgkmcnt(0)
  s_mov_b64 s[52:53], s[70:71]
  s_mov_b64 s[60:61], s[64:65]
  s_mov_b64 s[44:45], s[66:67]
  s_mov_b64 s[48:49], s[68:69]
  buffer_load_dwordx4 a[0:3], v95, s[52:55], s95 offen
  s_add_u32 s95, s95, s22
  buffer_load_dwordx4 a[4:7], v95, s[52:55], s95 offen
  s_add_u32 s95, s95, s22
  buffer_load_dwordx4 a[8:11], v95, s[52:55], s95 offen
  s_add_u32 s95, s95, s22
  buffer_load_dwordx4 a[12:15], v95, s[52:55], s95 offen
  s_add_u32 s95, s95, s22
  buffer_load_dwordx4 a[16:19], v95, s[52:55], s95 offen
  s_add_u32 s95, s95, s22
  buffer_load_dwordx4 a[20:23], v95, s[52:55], s95 offen
  s_add_u32 s95, s95, s22
  buffer_load_dwordx4 a[24:27], v95, s[52:55], s95 offen
  s_add_u32 s95, s95, s22
  buffer_load_dwordx4 a[28:31], v95, s[52:55], s95 offen
  s_load_dwordx2 s[76:77], s[0:1], 96
  s_load_dwordx2 s[56:57], s[0:1], 32
  s_load_dwordx2 s[68:69], s[0:1], 64
  s_load_dwordx2 s[72:73], s[0:1], 72
  s_load_dwordx2 s[84:85], s[0:1], 80
  s_load_dwordx2 s[80:81], s[0:1], 88
  s_load_dwordx4 s[28:31], s[0:1], 48
  s_lshl_b32 s94, s16, 8
  buffer_load_dwordx4 v[32:35], v94, s[60:63], s94 offen
  s_lshl_b32 s94, s17, 8
  buffer_load_dwordx4 v[36:39], v94, s[60:63], s94 offen
  s_lshl_b32 s94, s18, 8
  buffer_load_dwordx4 v[40:43], v94, s[60:63], s94 offen
  s_lshl_b32 s94, s19, 8
  buffer_load_dwordx4 v[44:47], v94, s[60:63], s94 offen
  s_lshl_b32 s94, s20, 8
  buffer_load_dwordx4 v[48:51], v94, s[60:63], s94 offen
  s_and_b32 s6, s21, 3
  s_lshl_b32 s8, s5, 5
  s_add_u32 s7, s8, s4
  s_lshl_b32 s8, s7, 21
  s_lshl_b32 s9, s6, 19
  s_add_u32 s8, s8, s9
  s_lshl_b32 s9, s3, 12
  s_add_u32 s8, s8, s9
  v_lshlrev_b32 v9, 4, v0
  v_add_u32 v9, s8, v9
  s_mov_b32 s46, 134217728
  s_mov_b32 s47, 0x20000
  s_mov_b32 s78, 536870912
  s_mov_b32 s79, 0x20000
  s_and_b32 s23, s2, 31
  s_lshl_b32 s23, s23, 14
  s_mul_i32 s8, s3, 40
  v_add_u32 v4, s8, v0
  v_lshrrev_b32 v5, 3, v4
  v_and_b32 v6, 7, v4
  v_lshlrev_b32 v5, 14, v5
  v_lshl_add_u32 v15, v6, 4, v5
  s_mul_i32 s8, s5, 327680
  s_lshl_b32 s9, s4, 2
  s_add_u32 s9, s9, s6
  s_lshl_b32 s10, s9, 7
  s_add_u32 s8, s8, s10
  s_add_u32 s8, s8, 65536
  v_add_u32 v15, s8, v15
  v_lshlrev_b32 v14, 4, v4
  s_lshl_b32 s8, s7, 9
  s_lshl_b32 s9, s6, 7
  s_lshl_b32 s10, s3, 4
  s_add_u32 s9, s9, s10
  s_add_u32 s9, s9, s8
  v_mov_b32 v84, s9
  v_cmp_gt_u32 vcc, 40, v0
  v_mov_b32 v88, -1
  v_mov_b32 v89, -1
  v_mov_b32 v90, -1
  v_mov_b32 v91, -1
  v_cndmask_b32 v5, v84, v15, vcc
  s_waitcnt lgkmcnt(0)
  s_mov_b32 exec_hi, 0x1ff
  buffer_store_dwordx4 v[88:91], v5, s[76:79], 0 offen sc1
  s_mov_b32 exec_hi, -1
  v_bfe_u32 v5, v0, 2, 2
  v_and_b32 v6, 3, v0
  v_lshlrev_b32 v5, 7, v5
  v_lshl_add_u32 v85, v6, 4, v5
  v_add_u32 v85, s8, v85
  v_lshrrev_b32 v4, 3, v3
  v_and_b32 v5, 7, v3
  v_and_b32 v6, 1, v2
  v_lshlrev_b32 v6, 4, v6
  v_lshrrev_b32 v7, 5, v0
  v_lshl_add_u32 v13, v7, 3, v6
  v_and_b32 v1, 1, v3
  v_lshl_add_u32 v1, v1, 5, v13
  v_bfe_u32 v8, v3, 1, 2
  v_lshl_add_u32 v1, v8, 7, v1
  v_lshl_add_u32 v1, v4, 13, v1
  s_lshl_b32 s8, s4, 14
  s_add_u32 s8, s8, 1048576
  s_lshl_b32 s9, s21, 10
  s_and_b32 s10, s3, 1
  s_lshl_b32 s11, s10, 9
  s_add_u32 s9, s9, s11
  s_lshr_b32 s11, s3, 1
  s_lshl_b32 s11, s11, 6
  s_add_u32 s9, s9, s11
  s_add_u32 s9, s9, s8
  v_add_u32 v1, s9, v1
  buffer_store_dwordx2 v[88:89], v1, s[76:79], 0 offen sc1
  s_lshl_b32 s9, s5, 13
  s_add_u32 s8, s8, s9
  s_lshl_b32 s9, s6, 7
  s_add_u32 s8, s8, s9
  v_lshrrev_b32 v8, 3, v0
  v_lshlrev_b32 v8, 9, v8
  v_lshl_add_u32 v8, v5, 4, v8
  v_add_u32 v8, s8, v8
  s_lshl_b32 s8, s3, 1
  v_add_u32 v7, s8, v7
  v_mul_u32_u24 v7, 528, v7
  v_lshl_add_u32 v6, v3, 5, v6
  v_add_u32 v11, v7, v6
  v_lshl_add_u32 v13, v3, 5, v13
  s_mul_i32 s8, s3, 2560
  v_add_u32 v13, s8, v13
  v_mul_u32_u24 v5, 528, v5
  v_lshl_add_u32 v5, v4, 4, v5
  v_lshl_add_u32 v5, v2, 5, v5
  s_lshl_b32 s8, s3, 7
  v_add_u32 v12, s8, v5
  s_mov_b32 s88, 0xcccccccc
  s_mov_b32 s89, s88
  s_mov_b32 s90, 0xaaaaaaaa
  s_mov_b32 s91, s90
  s_mov_b32 s92, 0
  s_mov_b32 s93, -1
  v_mul_u32_u24 v4, 0x202, v4
  v_add_u32 v4, 0x100, v4
  v_or_b32 v5, 0x0c0c0000, v4
  v_lshlrev_b32 v4, 16, v4
  v_or_b32 v4, 0x0c0c, v4
  v_cndmask_b32 v4, v5, v4, s[90:91]
  v_bfe_u32 v5, v0, 1, 2
  v_mov_b32 v7, 0x0c0c0c0c
  v_cmp_eq_u32 s[8:9], 0, v5
  v_cmp_eq_u32 s[10:11], 1, v5
  v_cmp_eq_u32 s[12:13], 2, v5
  v_cmp_eq_u32 s[14:15], 3, v5
  v_cndmask_b32 v16, v7, v4, s[8:9]
  v_cndmask_b32 v17, v7, v4, s[10:11]
  v_cndmask_b32 v18, v7, v4, s[12:13]
  v_cndmask_b32 v19, v7, v4, s[14:15]
  s_lshl_b32 s95, s17, 20
  buffer_load_dwordx4 a[32:35], v95, s[52:55], s95 offen
  s_add_u32 s95, s95, s22
  buffer_load_dwordx4 a[36:39], v95, s[52:55], s95 offen
  s_add_u32 s95, s95, s22
  buffer_load_dwordx4 a[40:43], v95, s[52:55], s95 offen
  s_add_u32 s95, s95, s22
  buffer_load_dwordx4 a[44:47], v95, s[52:55], s95 offen
  s_add_u32 s95, s95, s22
  buffer_load_dwordx4 a[48:51], v95, s[52:55], s95 offen
  s_add_u32 s95, s95, s22
  buffer_load_dwordx4 a[52:55], v95, s[52:55], s95 offen
  s_add_u32 s95, s95, s22
  buffer_load_dwordx4 a[56:59], v95, s[52:55], s95 offen
  s_add_u32 s95, s95, s22
  buffer_load_dwordx4 a[60:63], v95, s[52:55], s95 offen
  s_lshl_b32 s95, s18, 20
  buffer_load_dwordx4 a[64:67], v95, s[52:55], s95 offen
  s_add_u32 s95, s95, s22
  buffer_load_dwordx4 a[68:71], v95, s[52:55], s95 offen
  s_add_u32 s95, s95, s22
  buffer_load_dwordx4 a[72:75], v95, s[52:55], s95 offen
  s_add_u32 s95, s95, s22
  buffer_load_dwordx4 a[76:79], v95, s[52:55], s95 offen
  s_add_u32 s95, s95, s22
  buffer_load_dwordx4 a[80:83], v95, s[52:55], s95 offen
  s_add_u32 s95, s95, s22
  buffer_load_dwordx4 a[84:87], v95, s[52:55], s95 offen
  s_add_u32 s95, s95, s22
  buffer_load_dwordx4 a[88:91], v95, s[52:55], s95 offen
  s_add_u32 s95, s95, s22
  buffer_load_dwordx4 a[92:95], v95, s[52:55], s95 offen
  s_lshl_b32 s95, s19, 20
  buffer_load_dwordx4 a[96:99], v95, s[52:55], s95 offen
  s_add_u32 s95, s95, s22
  buffer_load_dwordx4 a[100:103], v95, s[52:55], s95 offen
  s_add_u32 s95, s95, s22
  buffer_load_dwordx4 a[104:107], v95, s[52:55], s95 offen
  s_add_u32 s95, s95, s22
  buffer_load_dwordx4 a[108:111], v95, s[52:55], s95 offen
  s_add_u32 s95, s95, s22
  buffer_load_dwordx4 a[112:115], v95, s[52:55], s95 offen
  s_add_u32 s95, s95, s22
  buffer_load_dwordx4 a[116:119], v95, s[52:55], s95 offen
  s_add_u32 s95, s95, s22
  buffer_load_dwordx4 a[120:123], v95, s[52:55], s95 offen
  s_add_u32 s95, s95, s22
  buffer_load_dwordx4 a[124:127], v95, s[52:55], s95 offen
  s_lshl_b32 s95, s20, 20
  buffer_load_dwordx4 a[128:131], v95, s[52:55], s95 offen
  s_add_u32 s95, s95, s22
  buffer_load_dwordx4 a[132:135], v95, s[52:55], s95 offen
  s_add_u32 s95, s95, s22
  buffer_load_dwordx4 a[136:139], v95, s[52:55], s95 offen
  s_add_u32 s95, s95, s22
  buffer_load_dwordx4 a[140:143], v95, s[52:55], s95 offen
  s_add_u32 s95, s95, s22
  buffer_load_dwordx4 a[144:147], v95, s[52:55], s95 offen
  s_add_u32 s95, s95, s22
  buffer_load_dwordx4 a[148:151], v95, s[52:55], s95 offen
  s_add_u32 s95, s95, s22
  buffer_load_dwordx4 a[152:155], v95, s[52:55], s95 offen
  s_add_u32 s95, s95, s22
  buffer_load_dwordx4 a[156:159], v95, s[52:55], s95 offen
  s_mov_b32 s50, 134217728
  s_mov_b32 s51, 0x20000
  s_mov_b32 s58, 5242880
  s_mov_b32 s59, 0x20000
  s_mov_b32 s70, 2211840
  s_mov_b32 s71, 0x20000
  s_mov_b32 s74, 1280
  s_mov_b32 s75, 0x20000
  s_mov_b32 s86, 2560
  s_mov_b32 s87, 0x20000
  s_mov_b32 s82, 256
  s_mov_b32 s83, 0x20000
  s_cmp_lt_u32 s3, 2
  s_cselect_b32 s64, s28, s30
  s_cselect_b32 s65, s29, s31
  s_cmp_lt_u32 s4, 27
  s_cselect_b32 s66, 2211840, 0
  s_mov_b32 s67, 0x20000
  s_waitcnt vmcnt(34)
  v_perm_b32 v56, v32, v32, v16
  v_perm_b32 v57, v32, v32, v17
  v_perm_b32 v58, v32, v32, v18
  v_perm_b32 v59, v32, v32, v19
  s_xor_b32 s94, s23, 0
  buffer_load_dwordx4 v[112:115], v9, s[44:47], s94 offen offset:0 nt
  v_mfma_f32_16x16x32_bf16 v[64:67], v[56:59], a[0:3], 0
  v_mfma_f32_16x16x32_bf16 v[68:71], v[56:59], a[4:7], 0
  v_perm_b32 v60, v33, v33, v16
  v_perm_b32 v61, v33, v33, v17
  v_perm_b32 v62, v33, v33, v18
  v_perm_b32 v63, v33, v33, v19
  buffer_load_dwordx4 v[116:119], v9, s[44:47], s94 offen offset:1024 nt
  buffer_load_dwordx4 v[120:123], v9, s[44:47], s94 offen offset:2048 nt
  v_mfma_f32_16x16x32_bf16 v[64:67], v[60:63], a[8:11], v[64:67]
  v_mfma_f32_16x16x32_bf16 v[68:71], v[60:63], a[12:15], v[68:71]
  v_perm_b32 v56, v34, v34, v16
  v_perm_b32 v57, v34, v34, v17
  v_perm_b32 v58, v34, v34, v18
  v_perm_b32 v59, v34, v34, v19
  buffer_load_dwordx4 v[124:127], v9, s[44:47], s94 offen offset:3072 nt
  s_xor_b32 s94, s23, 16384
  buffer_load_dwordx4 v[128:131], v9, s[44:47], s94 offen offset:0 nt
  v_mfma_f32_16x16x32_bf16 v[64:67], v[56:59], a[16:19], v[64:67]
  v_mfma_f32_16x16x32_bf16 v[68:71], v[56:59], a[20:23], v[68:71]
  v_perm_b32 v60, v35, v35, v16
  v_perm_b32 v61, v35, v35, v17
  v_perm_b32 v62, v35, v35, v18
  v_perm_b32 v63, v35, v35, v19
  buffer_load_dwordx4 v[132:135], v9, s[44:47], s94 offen offset:1024 nt
  buffer_load_dwordx4 v[136:139], v9, s[44:47], s94 offen offset:2048 nt
  v_mfma_f32_16x16x32_bf16 v[64:67], v[60:63], a[24:27], v[64:67]
  v_mfma_f32_16x16x32_bf16 v[68:71], v[60:63], a[28:31], v[68:71]
  v_perm_b32 v56, v36, v36, v16
  v_perm_b32 v57, v36, v36, v17
  v_perm_b32 v58, v36, v36, v18
  v_perm_b32 v59, v36, v36, v19
  buffer_load_dwordx4 v[140:143], v9, s[44:47], s94 offen offset:3072 nt
  s_xor_b32 s94, s23, 32768
  buffer_load_dwordx4 v[144:147], v9, s[44:47], s94 offen offset:0 nt
  s_waitcnt vmcnt(40)
  v_mfma_f32_16x16x32_bf16 v[64:67], v[56:59], a[32:35], v[64:67]
  s_waitcnt vmcnt(39)
  v_mfma_f32_16x16x32_bf16 v[68:71], v[56:59], a[36:39], v[68:71]
  v_perm_b32 v60, v37, v37, v16
  v_perm_b32 v61, v37, v37, v17
  v_perm_b32 v62, v37, v37, v18
  v_perm_b32 v63, v37, v37, v19
  buffer_load_dwordx4 v[148:151], v9, s[44:47], s94 offen offset:1024 nt
  s_waitcnt vmcnt(39)
  v_mfma_f32_16x16x32_bf16 v[64:67], v[60:63], a[40:43], v[64:67]
  s_waitcnt vmcnt(38)
  v_mfma_f32_16x16x32_bf16 v[68:71], v[60:63], a[44:47], v[68:71]
  v_perm_b32 v56, v38, v38, v16
  v_perm_b32 v57, v38, v38, v17
  v_perm_b32 v58, v38, v38, v18
  v_perm_b32 v59, v38, v38, v19
  buffer_load_dwordx4 v[152:155], v9, s[44:47], s94 offen offset:2048 nt
  buffer_load_dwordx4 v[156:159], v9, s[44:47], s94 offen offset:3072 nt
  s_waitcnt vmcnt(39)
  v_mfma_f32_16x16x32_bf16 v[64:67], v[56:59], a[48:51], v[64:67]
  s_waitcnt vmcnt(38)
  v_mfma_f32_16x16x32_bf16 v[68:71], v[56:59], a[52:55], v[68:71]
  v_perm_b32 v60, v39, v39, v16
  v_perm_b32 v61, v39, v39, v17
  v_perm_b32 v62, v39, v39, v18
  v_perm_b32 v63, v39, v39, v19
  s_xor_b32 s94, s23, 49152
  buffer_load_dwordx4 v[160:163], v9, s[44:47], s94 offen offset:0 nt
  buffer_load_dwordx4 v[164:167], v9, s[44:47], s94 offen offset:1024 nt
  s_waitcnt vmcnt(39)
  v_mfma_f32_16x16x32_bf16 v[64:67], v[60:63], a[56:59], v[64:67]
  s_waitcnt vmcnt(38)
  v_mfma_f32_16x16x32_bf16 v[68:71], v[60:63], a[60:63], v[68:71]
  v_perm_b32 v56, v40, v40, v16
  v_perm_b32 v57, v40, v40, v17
  v_perm_b32 v58, v40, v40, v18
  v_perm_b32 v59, v40, v40, v19
  buffer_load_dwordx4 v[168:171], v9, s[44:47], s94 offen offset:2048 nt
  buffer_load_dwordx4 v[172:175], v9, s[44:47], s94 offen offset:3072 nt
  s_waitcnt vmcnt(39)
  v_mfma_f32_16x16x32_bf16 v[64:67], v[56:59], a[64:67], v[64:67]
  s_waitcnt vmcnt(38)
  v_mfma_f32_16x16x32_bf16 v[68:71], v[56:59], a[68:71], v[68:71]
  v_perm_b32 v60, v41, v41, v16
  v_perm_b32 v61, v41, v41, v17
  v_perm_b32 v62, v41, v41, v18
  v_perm_b32 v63, v41, v41, v19
  s_xor_b32 s94, s23, 65536
  buffer_load_dwordx4 v[176:179], v9, s[44:47], s94 offen offset:0 nt
  buffer_load_dwordx4 v[180:183], v9, s[44:47], s94 offen offset:1024 nt
  s_waitcnt vmcnt(39)
  v_mfma_f32_16x16x32_bf16 v[64:67], v[60:63], a[72:75], v[64:67]
  s_waitcnt vmcnt(38)
  v_mfma_f32_16x16x32_bf16 v[68:71], v[60:63], a[76:79], v[68:71]
  v_perm_b32 v56, v42, v42, v16
  v_perm_b32 v57, v42, v42, v17
  v_perm_b32 v58, v42, v42, v18
  v_perm_b32 v59, v42, v42, v19
  buffer_load_dwordx4 v[184:187], v9, s[44:47], s94 offen offset:2048 nt
  s_waitcnt vmcnt(38)
  v_mfma_f32_16x16x32_bf16 v[64:67], v[56:59], a[80:83], v[64:67]
  s_waitcnt vmcnt(37)
  v_mfma_f32_16x16x32_bf16 v[68:71], v[56:59], a[84:87], v[68:71]
  v_perm_b32 v60, v43, v43, v16
  v_perm_b32 v61, v43, v43, v17
  v_perm_b32 v62, v43, v43, v18
  v_perm_b32 v63, v43, v43, v19
  buffer_load_dwordx4 v[188:191], v9, s[44:47], s94 offen offset:3072 nt
  s_xor_b32 s94, s23, 81920
  buffer_load_dwordx4 v[192:195], v9, s[44:47], s94 offen offset:0 nt
  s_waitcnt vmcnt(38)
  v_mfma_f32_16x16x32_bf16 v[64:67], v[60:63], a[88:91], v[64:67]
  s_waitcnt vmcnt(37)
  v_mfma_f32_16x16x32_bf16 v[68:71], v[60:63], a[92:95], v[68:71]
  v_perm_b32 v56, v44, v44, v16
  v_perm_b32 v57, v44, v44, v17
  v_perm_b32 v58, v44, v44, v18
  v_perm_b32 v59, v44, v44, v19
  buffer_load_dwordx4 v[196:199], v9, s[44:47], s94 offen offset:1024 nt
  buffer_load_dwordx4 v[200:203], v9, s[44:47], s94 offen offset:2048 nt
  s_waitcnt vmcnt(38)
  v_mfma_f32_16x16x32_bf16 v[64:67], v[56:59], a[96:99], v[64:67]
  s_waitcnt vmcnt(37)
  v_mfma_f32_16x16x32_bf16 v[68:71], v[56:59], a[100:103], v[68:71]
  v_perm_b32 v60, v45, v45, v16
  v_perm_b32 v61, v45, v45, v17
  v_perm_b32 v62, v45, v45, v18
  v_perm_b32 v63, v45, v45, v19
  buffer_load_dwordx4 v[204:207], v9, s[44:47], s94 offen offset:3072 nt
  s_xor_b32 s94, s23, 98304
  buffer_load_dwordx4 v[208:211], v9, s[44:47], s94 offen offset:0 nt
  s_waitcnt vmcnt(38)
  v_mfma_f32_16x16x32_bf16 v[64:67], v[60:63], a[104:107], v[64:67]
  s_waitcnt vmcnt(37)
  v_mfma_f32_16x16x32_bf16 v[68:71], v[60:63], a[108:111], v[68:71]
  v_perm_b32 v56, v46, v46, v16
  v_perm_b32 v57, v46, v46, v17
  v_perm_b32 v58, v46, v46, v18
  v_perm_b32 v59, v46, v46, v19
  buffer_load_dwordx4 v[212:215], v9, s[44:47], s94 offen offset:1024 nt
  buffer_load_dwordx4 v[216:219], v9, s[44:47], s94 offen offset:2048 nt
  s_waitcnt vmcnt(38)
  v_mfma_f32_16x16x32_bf16 v[64:67], v[56:59], a[112:115], v[64:67]
  s_waitcnt vmcnt(37)
  v_mfma_f32_16x16x32_bf16 v[68:71], v[56:59], a[116:119], v[68:71]
  v_perm_b32 v60, v47, v47, v16
  v_perm_b32 v61, v47, v47, v17
  v_perm_b32 v62, v47, v47, v18
  v_perm_b32 v63, v47, v47, v19
  buffer_load_dwordx4 v[220:223], v9, s[44:47], s94 offen offset:3072 nt
  s_waitcnt vmcnt(37)
  v_mfma_f32_16x16x32_bf16 v[64:67], v[60:63], a[120:123], v[64:67]
  s_waitcnt vmcnt(36)
  v_mfma_f32_16x16x32_bf16 v[68:71], v[60:63], a[124:127], v[68:71]
  v_perm_b32 v56, v48, v48, v16
  v_perm_b32 v57, v48, v48, v17
  v_perm_b32 v58, v48, v48, v18
  v_perm_b32 v59, v48, v48, v19
  s_xor_b32 s94, s23, 114688
  buffer_load_dwordx4 v[224:227], v9, s[44:47], s94 offen offset:0 nt
  buffer_load_dwordx4 v[228:231], v9, s[44:47], s94 offen offset:1024 nt
  s_waitcnt vmcnt(37)
  v_mfma_f32_16x16x32_bf16 v[64:67], v[56:59], a[128:131], v[64:67]
  s_waitcnt vmcnt(36)
  v_mfma_f32_16x16x32_bf16 v[68:71], v[56:59], a[132:135], v[68:71]
  v_perm_b32 v60, v49, v49, v16
  v_perm_b32 v61, v49, v49, v17
  v_perm_b32 v62, v49, v49, v18
  v_perm_b32 v63, v49, v49, v19
  buffer_load_dwordx4 v[232:235], v9, s[44:47], s94 offen offset:2048 nt
  buffer_load_dwordx4 v[236:239], v9, s[44:47], s94 offen offset:3072 nt
  s_waitcnt vmcnt(37)
  v_mfma_f32_16x16x32_bf16 v[64:67], v[60:63], a[136:139], v[64:67]
  s_waitcnt vmcnt(36)
  v_mfma_f32_16x16x32_bf16 v[68:71], v[60:63], a[140:143], v[68:71]
  v_perm_b32 v56, v50, v50, v16
  v_perm_b32 v57, v50, v50, v17
  v_perm_b32 v58, v50, v50, v18
  v_perm_b32 v59, v50, v50, v19
  s_xor_b32 s94, s23, 131072
  buffer_load_dwordx4 v[240:243], v9, s[44:47], s94 offen offset:0 nt
  buffer_load_dwordx4 v[244:247], v9, s[44:47], s94 offen offset:1024 nt
  s_waitcnt vmcnt(37)
  v_mfma_f32_16x16x32_bf16 v[64:67], v[56:59], a[144:147], v[64:67]
  s_waitcnt vmcnt(36)
  v_mfma_f32_16x16x32_bf16 v[68:71], v[56:59], a[148:151], v[68:71]
  v_perm_b32 v60, v51, v51, v16
  v_perm_b32 v61, v51, v51, v17
  v_perm_b32 v62, v51, v51, v18
  v_perm_b32 v63, v51, v51, v19
  buffer_load_dwordx4 v[248:251], v9, s[44:47], s94 offen offset:2048 nt
  buffer_load_dwordx4 v[252:255], v9, s[44:47], s94 offen offset:3072 nt
  s_waitcnt vmcnt(37)
  v_mfma_f32_16x16x32_bf16 v[64:67], v[60:63], a[152:155], v[64:67]
  s_waitcnt vmcnt(36)
  v_mfma_f32_16x16x32_bf16 v[68:71], v[60:63], a[156:159], v[68:71]
  s_lshl_b32 s8, s4, 7
  s_lshl_b32 s9, s3, 5
  s_add_u32 s8, s8, s9
  s_mul_i32 s8, s8, 1280
  v_mul_u32_u24 v4, 10240, v2
  v_lshl_add_u32 v4, v3, 4, v4
  v_add_u32 v10, s8, v4
  v_lshlrev_b32 v86, 2, v0
  v_cndmask_b32 v64, v64, v68, s[92:93]
  v_cndmask_b32 v65, v65, v69, s[92:93]
  v_cndmask_b32 v66, v66, v70, s[92:93]
  v_cndmask_b32 v67, v67, v71, s[92:93]
  ds_write_b128 v11, v[64:67] offset:0
  v_lshlrev_b32 v4, 3, v0
  s_waitcnt lgkmcnt(0)
  s_barrier
  ds_read_b64 v[64:65], v4 offset:0
  ds_read_b64 v[66:67], v4 offset:528
  ds_read_b64 v[68:69], v4 offset:1056
  ds_read_b64 v[70:71], v4 offset:1584
  ds_read_b64 v[72:73], v4 offset:2112
  ds_read_b64 v[74:75], v4 offset:2640
  ds_read_b64 v[76:77], v4 offset:3168
  ds_read_b64 v[78:79], v4 offset:3696
  s_cmp_eq_u32 s3, 0
  s_cbranch_scc0 L_noinit
  s_lshl_b32 s8, s7, 2
  v_mov_b32 v5, s8
  v_mov_b32 v6, 1
  s_mov_b64 exec, 1
  buffer_atomic_add v6, v5, s[80:83], 0 offen sc1
  s_mov_b64 exec, -1
L_noinit:
  s_lshl_b32 s8, s3, 8
  v_add_u32 v5, s8, v86
  v_lshlrev_b32 v6, 4, v3
  v_add_u32 v6, s8, v6
  s_waitcnt lgkmcnt(0)
  v_add_f32 v64, v64, v66
  v_add_f32 v65, v65, v67
  v_add_f32 v68, v68, v70
  v_add_f32 v69, v69, v71
  v_add_f32 v72, v72, v74
  v_add_f32 v73, v73, v75
  v_add_f32 v76, v76, v78
  v_add_f32 v77, v77, v79
  v_add_f32 v64, v64, v68
  v_add_f32 v65, v65, v69
  v_add_f32 v72, v72, v76
  v_add_f32 v73, v73, v77
  v_add_f32 v64, v64, v72
  v_add_f32 v65, v65, v73
  v_cvt_pk_bf16_f32 v7, v64, v65
  ds_write_b32 v5, v7 offset:4352
  ds_read_b128 v[20:23], v6 offset:4352
  s_waitcnt lgkmcnt(0)
  s_waitcnt vmcnt(35)
  v_dot2_f32_bf16 v64, v112, v20, 0
  v_dot2_f32_bf16 v64, v113, v21, v64
  v_dot2_f32_bf16 v64, v114, v22, v64
  v_dot2_f32_bf16 v64, v115, v23, v64
  s_waitcnt vmcnt(34)
  v_dot2_f32_bf16 v65, v116, v20, 0
  v_dot2_f32_bf16 v65, v117, v21, v65
  v_dot2_f32_bf16 v65, v118, v22, v65
  v_dot2_f32_bf16 v65, v119, v23, v65
  s_waitcnt vmcnt(33)
  v_dot2_f32_bf16 v66, v120, v20, 0
  v_dot2_f32_bf16 v66, v121, v21, v66
  v_dot2_f32_bf16 v66, v122, v22, v66
  v_dot2_f32_bf16 v66, v123, v23, v66
  s_waitcnt vmcnt(32)
  v_dot2_f32_bf16 v67, v124, v20, 0
  v_dot2_f32_bf16 v67, v125, v21, v67
  v_dot2_f32_bf16 v67, v126, v22, v67
  v_dot2_f32_bf16 v67, v127, v23, v67
  s_waitcnt vmcnt(31)
  v_dot2_f32_bf16 v68, v128, v20, 0
  v_dot2_f32_bf16 v68, v129, v21, v68
  v_dot2_f32_bf16 v68, v130, v22, v68
  v_dot2_f32_bf16 v68, v131, v23, v68
  s_waitcnt vmcnt(30)
  v_dot2_f32_bf16 v69, v132, v20, 0
  v_dot2_f32_bf16 v69, v133, v21, v69
  v_dot2_f32_bf16 v69, v134, v22, v69
  v_dot2_f32_bf16 v69, v135, v23, v69
  s_waitcnt vmcnt(29)
  v_dot2_f32_bf16 v70, v136, v20, 0
  v_dot2_f32_bf16 v70, v137, v21, v70
  v_dot2_f32_bf16 v70, v138, v22, v70
  v_dot2_f32_bf16 v70, v139, v23, v70
  s_waitcnt vmcnt(28)
  v_dot2_f32_bf16 v71, v140, v20, 0
  v_dot2_f32_bf16 v71, v141, v21, v71
  v_dot2_f32_bf16 v71, v142, v22, v71
  v_dot2_f32_bf16 v71, v143, v23, v71
  s_waitcnt vmcnt(27)
  v_dot2_f32_bf16 v72, v144, v20, 0
  v_dot2_f32_bf16 v72, v145, v21, v72
  v_dot2_f32_bf16 v72, v146, v22, v72
  v_dot2_f32_bf16 v72, v147, v23, v72
  s_waitcnt vmcnt(26)
  v_dot2_f32_bf16 v73, v148, v20, 0
  v_dot2_f32_bf16 v73, v149, v21, v73
  v_dot2_f32_bf16 v73, v150, v22, v73
  v_dot2_f32_bf16 v73, v151, v23, v73
  s_waitcnt vmcnt(25)
  v_dot2_f32_bf16 v74, v152, v20, 0
  v_dot2_f32_bf16 v74, v153, v21, v74
  v_dot2_f32_bf16 v74, v154, v22, v74
  v_dot2_f32_bf16 v74, v155, v23, v74
  s_waitcnt vmcnt(24)
  v_dot2_f32_bf16 v75, v156, v20, 0
  v_dot2_f32_bf16 v75, v157, v21, v75
  v_dot2_f32_bf16 v75, v158, v22, v75
  v_dot2_f32_bf16 v75, v159, v23, v75
  s_waitcnt vmcnt(23)
  v_dot2_f32_bf16 v76, v160, v20, 0
  v_dot2_f32_bf16 v76, v161, v21, v76
  v_dot2_f32_bf16 v76, v162, v22, v76
  v_dot2_f32_bf16 v76, v163, v23, v76
  s_waitcnt vmcnt(22)
  v_dot2_f32_bf16 v77, v164, v20, 0
  v_dot2_f32_bf16 v77, v165, v21, v77
  v_dot2_f32_bf16 v77, v166, v22, v77
  v_dot2_f32_bf16 v77, v167, v23, v77
  s_mul_i32 s8, s21, 80
  s_and_b32 s9, s3, 1
  s_mul_i32 s9, s9, 40
  s_add_u32 s8, s8, s9
  v_mul_u32_u24 v92, 10, v2
  v_add_u32 v92, s8, v92
  v_lshrrev_b32 v93, 3, v3
  v_add_u32 v93, v93, v92
  v_mul_u32_u24 v93, 3456, v93
  v_and_b32 v94, 7, v3
  v_lshl_add_u32 v93, v94, 4, v93
  s_lshl_b32 s9, s4, 7
  buffer_load_dwordx4 a[180:183], v93, s[64:67], s9 offen
  s_add_u32 s9, s9, 6912
  buffer_load_dwordx4 a[184:187], v93, s[64:67], s9 offen
  s_add_u32 s9, s9, 6912
  buffer_load_dwordx4 a[188:191], v93, s[64:67], s9 offen
  s_add_u32 s9, s9, 6912
  buffer_load_dwordx4 a[192:195], v93, s[64:67], s9 offen
  s_add_u32 s9, s9, 6912
  buffer_load_dwordx4 a[196:199], v93, s[64:67], s9 offen
  v_lshlrev_b32 v92, 1, v92
  buffer_load_dwordx4 v[112:115], v92, s[60:63], 0 offen
  buffer_load_dword v128, v92, s[60:63], 0 offen offset:16
  buffer_load_dwordx4 v[116:119], v92, s[60:63], 0 offen offset:1280
  buffer_load_dword v129, v92, s[60:63], 0 offen offset:1296
  v_mul_u32_u24 v94, 20, v0
  s_mul_i32 s9, s5, 1280
  buffer_load_dwordx4 v[120:123], v94, s[60:63], s9 offen
  buffer_load_dword v130, v94, s[60:63], s9 offen offset:16
  buffer_load_dwordx4 v[124:127], v94, s[72:75], 0 offen
  buffer_load_dword v131, v94, s[72:75], 0 offen offset:16
  s_lshl_b32 s8, s4, 6
  s_lshl_b32 s9, s6, 4
  s_add_u32 s8, s8, s9
  s_lshl_b32 s9, s3, 2
  s_add_u32 s8, s8, s9
  s_mul_i32 s8, s8, 1280
  v_mul_u32_u24 v95, 1280, v2
  v_lshl_add_u32 v95, v3, 4, v95
  buffer_load_dwordx4 a[160:163], v95, s[68:71], s8 offen offset:0
  buffer_load_dwordx4 a[164:167], v95, s[68:71], s8 offen offset:256
  buffer_load_dwordx4 a[168:171], v95, s[68:71], s8 offen offset:512
  buffer_load_dwordx4 a[172:175], v95, s[68:71], s8 offen offset:768
  buffer_load_dwordx4 a[176:179], v95, s[68:71], s8 offen offset:1024
  s_waitcnt vmcnt(39)
  v_dot2_f32_bf16 v78, v168, v20, 0
  v_dot2_f32_bf16 v78, v169, v21, v78
  v_dot2_f32_bf16 v78, v170, v22, v78
  v_dot2_f32_bf16 v78, v171, v23, v78
  s_waitcnt vmcnt(38)
  v_dot2_f32_bf16 v79, v172, v20, 0
  v_dot2_f32_bf16 v79, v173, v21, v79
  v_dot2_f32_bf16 v79, v174, v22, v79
  v_dot2_f32_bf16 v79, v175, v23, v79
  v_add_f32_dpp v64, v64, v64 row_ror:8 row_mask:0xf bank_mask:0x3
  v_add_f32_dpp v65, v65, v65 row_ror:8 row_mask:0xf bank_mask:0x3
  v_add_f32_dpp v66, v66, v66 row_ror:8 row_mask:0xf bank_mask:0x3
  v_add_f32_dpp v67, v67, v67 row_ror:8 row_mask:0xf bank_mask:0x3
  v_add_f32_dpp v68, v68, v68 row_ror:8 row_mask:0xf bank_mask:0x3
  v_add_f32_dpp v69, v69, v69 row_ror:8 row_mask:0xf bank_mask:0x3
  v_add_f32_dpp v70, v70, v70 row_ror:8 row_mask:0xf bank_mask:0x3
  v_add_f32_dpp v71, v71, v71 row_ror:8 row_mask:0xf bank_mask:0x3
  v_add_f32_dpp v64, v72, v72 row_ror:8 row_mask:0xf bank_mask:0xc
  v_add_f32_dpp v65, v73, v73 row_ror:8 row_mask:0xf bank_mask:0xc
  v_add_f32_dpp v66, v74, v74 row_ror:8 row_mask:0xf bank_mask:0xc
  v_add_f32_dpp v67, v75, v75 row_ror:8 row_mask:0xf bank_mask:0xc
  v_add_f32_dpp v68, v76, v76 row_ror:8 row_mask:0xf bank_mask:0xc
  v_add_f32_dpp v69, v77, v77 row_ror:8 row_mask:0xf bank_mask:0xc
  v_add_f32_dpp v70, v78, v78 row_ror:8 row_mask:0xf bank_mask:0xc
  v_add_f32_dpp v71, v79, v79 row_ror:8 row_mask:0xf bank_mask:0xc
  v_add_f32_dpp v64, v64, v64 row_half_mirror row_mask:0xf bank_mask:0x5
  v_add_f32_dpp v65, v65, v65 row_half_mirror row_mask:0xf bank_mask:0x5
  v_add_f32_dpp v66, v66, v66 row_half_mirror row_mask:0xf bank_mask:0x5
  v_add_f32_dpp v67, v67, v67 row_half_mirror row_mask:0xf bank_mask:0x5
  v_add_f32_dpp v64, v68, v68 row_half_mirror row_mask:0xf bank_mask:0xa
  v_add_f32_dpp v65, v69, v69 row_half_mirror row_mask:0xf bank_mask:0xa
  v_add_f32_dpp v66, v70, v70 row_half_mirror row_mask:0xf bank_mask:0xa
  v_add_f32_dpp v67, v71, v71 row_half_mirror row_mask:0xf bank_mask:0xa
  v_cndmask_b32 v68, v66, v64, s[88:89]
  v_cndmask_b32 v69, v67, v65, s[88:89]
  v_cndmask_b32 v70, v64, v66, s[88:89]
  v_cndmask_b32 v71, v65, v67, s[88:89]
  v_add_f32_dpp v64, v68, v70 quad_perm:[2,3,0,1] row_mask:0xf bank_mask:0xf
  v_add_f32_dpp v65, v69, v71 quad_perm:[2,3,0,1] row_mask:0xf bank_mask:0xf
  v_cndmask_b32 v66, v65, v64, s[90:91]
  v_cndmask_b32 v67, v64, v65, s[90:91]
  s_nop 0
  v_add_f32_dpp v24, v66, v67 quad_perm:[1,0,3,2] row_mask:0xf bank_mask:0xf
  s_waitcnt vmcnt(37)
  v_dot2_f32_bf16 v64, v176, v20, 0
  v_dot2_f32_bf16 v64, v177, v21, v64
  v_dot2_f32_bf16 v64, v178, v22, v64
  v_dot2_f32_bf16 v64, v179, v23, v64
  s_waitcnt vmcnt(36)
  v_dot2_f32_bf16 v65, v180, v20, 0
  v_dot2_f32_bf16 v65, v181, v21, v65
  v_dot2_f32_bf16 v65, v182, v22, v65
  v_dot2_f32_bf16 v65, v183, v23, v65
  s_waitcnt vmcnt(35)
  v_dot2_f32_bf16 v66, v184, v20, 0
  v_dot2_f32_bf16 v66, v185, v21, v66
  v_dot2_f32_bf16 v66, v186, v22, v66
  v_dot2_f32_bf16 v66, v187, v23, v66
  s_waitcnt vmcnt(34)
  v_dot2_f32_bf16 v67, v188, v20, 0
  v_dot2_f32_bf16 v67, v189, v21, v67
  v_dot2_f32_bf16 v67, v190, v22, v67
  v_dot2_f32_bf16 v67, v191, v23, v67
  s_waitcnt vmcnt(33)
  v_dot2_f32_bf16 v68, v192, v20, 0
  v_dot2_f32_bf16 v68, v193, v21, v68
  v_dot2_f32_bf16 v68, v194, v22, v68
  v_dot2_f32_bf16 v68, v195, v23, v68
  s_waitcnt vmcnt(32)
  v_dot2_f32_bf16 v69, v196, v20, 0
  v_dot2_f32_bf16 v69, v197, v21, v69
  v_dot2_f32_bf16 v69, v198, v22, v69
  v_dot2_f32_bf16 v69, v199, v23, v69
  s_waitcnt vmcnt(31)
  v_dot2_f32_bf16 v70, v200, v20, 0
  v_dot2_f32_bf16 v70, v201, v21, v70
  v_dot2_f32_bf16 v70, v202, v22, v70
  v_dot2_f32_bf16 v70, v203, v23, v70
  s_waitcnt vmcnt(30)
  v_dot2_f32_bf16 v71, v204, v20, 0
  v_dot2_f32_bf16 v71, v205, v21, v71
  v_dot2_f32_bf16 v71, v206, v22, v71
  v_dot2_f32_bf16 v71, v207, v23, v71
  s_waitcnt vmcnt(29)
  v_dot2_f32_bf16 v72, v208, v20, 0
  v_dot2_f32_bf16 v72, v209, v21, v72
  v_dot2_f32_bf16 v72, v210, v22, v72
  v_dot2_f32_bf16 v72, v211, v23, v72
  s_xor_b32 s94, s23, 147456
  buffer_load_dwordx4 v[132:135], v9, s[44:47], s94 offen offset:0 nt
  s_waitcnt vmcnt(29)
  v_dot2_f32_bf16 v73, v212, v20, 0
  v_dot2_f32_bf16 v73, v213, v21, v73
  v_dot2_f32_bf16 v73, v214, v22, v73
  v_dot2_f32_bf16 v73, v215, v23, v73
  buffer_load_dwordx4 v[136:139], v9, s[44:47], s94 offen offset:1024 nt
  s_waitcnt vmcnt(29)
  v_dot2_f32_bf16 v74, v216, v20, 0
  v_dot2_f32_bf16 v74, v217, v21, v74
  v_dot2_f32_bf16 v74, v218, v22, v74
  v_dot2_f32_bf16 v74, v219, v23, v74
  buffer_load_dwordx4 v[140:143], v9, s[44:47], s94 offen offset:2048 nt
  s_waitcnt vmcnt(29)
  v_dot2_f32_bf16 v75, v220, v20, 0
  v_dot2_f32_bf16 v75, v221, v21, v75
  v_dot2_f32_bf16 v75, v222, v22, v75
  v_dot2_f32_bf16 v75, v223, v23, v75
  buffer_load_dwordx4 v[144:147], v9, s[44:47], s94 offen offset:3072 nt
  s_waitcnt vmcnt(29)
  v_dot2_f32_bf16 v76, v224, v20, 0
  v_dot2_f32_bf16 v76, v225, v21, v76
  v_dot2_f32_bf16 v76, v226, v22, v76
  v_dot2_f32_bf16 v76, v227, v23, v76
  s_xor_b32 s94, s23, 163840
  buffer_load_dwordx4 v[148:151], v9, s[44:47], s94 offen offset:0 nt
  s_waitcnt vmcnt(29)
  v_dot2_f32_bf16 v77, v228, v20, 0
  v_dot2_f32_bf16 v77, v229, v21, v77
  v_dot2_f32_bf16 v77, v230, v22, v77
  v_dot2_f32_bf16 v77, v231, v23, v77
  buffer_load_dwordx4 v[152:155], v9, s[44:47], s94 offen offset:1024 nt
  s_waitcnt vmcnt(29)
  v_dot2_f32_bf16 v78, v232, v20, 0
  v_dot2_f32_bf16 v78, v233, v21, v78
  v_dot2_f32_bf16 v78, v234, v22, v78
  v_dot2_f32_bf16 v78, v235, v23, v78
  buffer_load_dwordx4 v[156:159], v9, s[44:47], s94 offen offset:2048 nt
  s_waitcnt vmcnt(29)
  v_dot2_f32_bf16 v79, v236, v20, 0
  v_dot2_f32_bf16 v79, v237, v21, v79
  v_dot2_f32_bf16 v79, v238, v22, v79
  v_dot2_f32_bf16 v79, v239, v23, v79
  buffer_load_dwordx4 v[160:163], v9, s[44:47], s94 offen offset:3072 nt
  v_add_f32_dpp v64, v64, v64 row_ror:8 row_mask:0xf bank_mask:0x3
  v_add_f32_dpp v65, v65, v65 row_ror:8 row_mask:0xf bank_mask:0x3
  v_add_f32_dpp v66, v66, v66 row_ror:8 row_mask:0xf bank_mask:0x3
  v_add_f32_dpp v67, v67, v67 row_ror:8 row_mask:0xf bank_mask:0x3
  v_add_f32_dpp v68, v68, v68 row_ror:8 row_mask:0xf bank_mask:0x3
  v_add_f32_dpp v69, v69, v69 row_ror:8 row_mask:0xf bank_mask:0x3
  v_add_f32_dpp v70, v70, v70 row_ror:8 row_mask:0xf bank_mask:0x3
  v_add_f32_dpp v71, v71, v71 row_ror:8 row_mask:0xf bank_mask:0x3
  v_add_f32_dpp v64, v72, v72 row_ror:8 row_mask:0xf bank_mask:0xc
  v_add_f32_dpp v65, v73, v73 row_ror:8 row_mask:0xf bank_mask:0xc
  v_add_f32_dpp v66, v74, v74 row_ror:8 row_mask:0xf bank_mask:0xc
  v_add_f32_dpp v67, v75, v75 row_ror:8 row_mask:0xf bank_mask:0xc
  v_add_f32_dpp v68, v76, v76 row_ror:8 row_mask:0xf bank_mask:0xc
  v_add_f32_dpp v69, v77, v77 row_ror:8 row_mask:0xf bank_mask:0xc
  v_add_f32_dpp v70, v78, v78 row_ror:8 row_mask:0xf bank_mask:0xc
  v_add_f32_dpp v71, v79, v79 row_ror:8 row_mask:0xf bank_mask:0xc
  v_add_f32_dpp v64, v64, v64 row_half_mirror row_mask:0xf bank_mask:0x5
  v_add_f32_dpp v65, v65, v65 row_half_mirror row_mask:0xf bank_mask:0x5
  v_add_f32_dpp v66, v66, v66 row_half_mirror row_mask:0xf bank_mask:0x5
  v_add_f32_dpp v67, v67, v67 row_half_mirror row_mask:0xf bank_mask:0x5
  v_add_f32_dpp v64, v68, v68 row_half_mirror row_mask:0xf bank_mask:0xa
  v_add_f32_dpp v65, v69, v69 row_half_mirror row_mask:0xf bank_mask:0xa
  v_add_f32_dpp v66, v70, v70 row_half_mirror row_mask:0xf bank_mask:0xa
  v_add_f32_dpp v67, v71, v71 row_half_mirror row_mask:0xf bank_mask:0xa
  v_cndmask_b32 v68, v66, v64, s[88:89]
  v_cndmask_b32 v69, v67, v65, s[88:89]
  v_cndmask_b32 v70, v64, v66, s[88:89]
  v_cndmask_b32 v71, v65, v67, s[88:89]
  v_add_f32_dpp v64, v68, v70 quad_perm:[2,3,0,1] row_mask:0xf bank_mask:0xf
  v_add_f32_dpp v65, v69, v71 quad_perm:[2,3,0,1] row_mask:0xf bank_mask:0xf
  v_cndmask_b32 v66, v65, v64, s[90:91]
  v_cndmask_b32 v67, v64, v65, s[90:91]
  s_nop 0
  v_add_f32_dpp v25, v66, v67 quad_perm:[1,0,3,2] row_mask:0xf bank_mask:0xf
  v_cvt_pk_bf16_f32 v64, v24, v25
  v_lshlrev_b32 v24, 16, v64
  v_and_b32 v25, 0xffff0000, v64
  v_mul_f32 v24, 0x3db504f3, v24
  v_mul_f32 v25, 0x3db504f3, v25
  v_cvt_pk_bf16_f32 v64, v24, v25
  v_lshlrev_b32 v24, 16, v64
  v_and_b32 v25, 0xffff0000, v64
  s_waitcnt vmcnt(29)
  v_dot2_f32_bf16 v64, v240, v20, 0
  v_dot2_f32_bf16 v64, v241, v21, v64
  v_dot2_f32_bf16 v64, v242, v22, v64
  v_dot2_f32_bf16 v64, v243, v23, v64
  s_xor_b32 s94, s23, 180224
  buffer_load_dwordx4 v[164:167], v9, s[44:47], s94 offen offset:0 nt
  s_waitcnt vmcnt(29)
  v_dot2_f32_bf16 v65, v244, v20, 0
  v_dot2_f32_bf16 v65, v245, v21, v65
  v_dot2_f32_bf16 v65, v246, v22, v65
  v_dot2_f32_bf16 v65, v247, v23, v65
  buffer_load_dwordx4 v[168:171], v9, s[44:47], s94 offen offset:1024 nt
  s_waitcnt vmcnt(29)
  v_dot2_f32_bf16 v66, v248, v20, 0
  v_dot2_f32_bf16 v66, v249, v21, v66
  v_dot2_f32_bf16 v66, v250, v22, v66
  v_dot2_f32_bf16 v66, v251, v23, v66
  buffer_load_dwordx4 v[172:175], v9, s[44:47], s94 offen offset:2048 nt
  s_waitcnt vmcnt(29)
  v_dot2_f32_bf16 v67, v252, v20, 0
  v_dot2_f32_bf16 v67, v253, v21, v67
  v_dot2_f32_bf16 v67, v254, v22, v67
  v_dot2_f32_bf16 v67, v255, v23, v67
  buffer_load_dwordx4 v[176:179], v9, s[44:47], s94 offen offset:3072 nt
  s_waitcnt vmcnt(11)
  v_dot2_f32_bf16 v68, v132, v20, 0
  v_dot2_f32_bf16 v68, v133, v21, v68
  v_dot2_f32_bf16 v68, v134, v22, v68
  v_dot2_f32_bf16 v68, v135, v23, v68
  s_xor_b32 s94, s23, 196608
  buffer_load_dwordx4 v[180:183], v9, s[44:47], s94 offen offset:0 nt
  s_waitcnt vmcnt(11)
  v_dot2_f32_bf16 v69, v136, v20, 0
  v_dot2_f32_bf16 v69, v137, v21, v69
  v_dot2_f32_bf16 v69, v138, v22, v69
  v_dot2_f32_bf16 v69, v139, v23, v69
  buffer_load_dwordx4 v[184:187], v9, s[44:47], s94 offen offset:1024 nt
  s_waitcnt vmcnt(11)
  v_dot2_f32_bf16 v70, v140, v20, 0
  v_dot2_f32_bf16 v70, v141, v21, v70
  v_dot2_f32_bf16 v70, v142, v22, v70
  v_dot2_f32_bf16 v70, v143, v23, v70
  buffer_load_dwordx4 v[188:191], v9, s[44:47], s94 offen offset:2048 nt
  s_waitcnt vmcnt(11)
  v_dot2_f32_bf16 v71, v144, v20, 0
  v_dot2_f32_bf16 v71, v145, v21, v71
  v_dot2_f32_bf16 v71, v146, v22, v71
  v_dot2_f32_bf16 v71, v147, v23, v71
  buffer_load_dwordx4 v[192:195], v9, s[44:47], s94 offen offset:3072 nt
  s_waitcnt vmcnt(11)
  v_dot2_f32_bf16 v72, v148, v20, 0
  v_dot2_f32_bf16 v72, v149, v21, v72
  v_dot2_f32_bf16 v72, v150, v22, v72
  v_dot2_f32_bf16 v72, v151, v23, v72
  s_xor_b32 s94, s23, 212992
  buffer_load_dwordx4 v[196:199], v9, s[44:47], s94 offen offset:0 nt
  s_waitcnt vmcnt(11)
  v_dot2_f32_bf16 v73, v152, v20, 0
  v_dot2_f32_bf16 v73, v153, v21, v73
  v_dot2_f32_bf16 v73, v154, v22, v73
  v_dot2_f32_bf16 v73, v155, v23, v73
  buffer_load_dwordx4 v[200:203], v9, s[44:47], s94 offen offset:1024 nt
  s_waitcnt vmcnt(11)
  v_dot2_f32_bf16 v74, v156, v20, 0
  v_dot2_f32_bf16 v74, v157, v21, v74
  v_dot2_f32_bf16 v74, v158, v22, v74
  v_dot2_f32_bf16 v74, v159, v23, v74
  buffer_load_dwordx4 v[204:207], v9, s[44:47], s94 offen offset:2048 nt
  s_waitcnt vmcnt(11)
  v_dot2_f32_bf16 v75, v160, v20, 0
  v_dot2_f32_bf16 v75, v161, v21, v75
  v_dot2_f32_bf16 v75, v162, v22, v75
  v_dot2_f32_bf16 v75, v163, v23, v75
  buffer_load_dwordx4 v[208:211], v9, s[44:47], s94 offen offset:3072 nt
  s_waitcnt vmcnt(11)
  v_dot2_f32_bf16 v76, v164, v20, 0
  v_dot2_f32_bf16 v76, v165, v21, v76
  v_dot2_f32_bf16 v76, v166, v22, v76
  v_dot2_f32_bf16 v76, v167, v23, v76
  s_xor_b32 s94, s23, 229376
  buffer_load_dwordx4 v[212:215], v9, s[44:47], s94 offen offset:0 nt
  v_perm_b32 v56, v112, v112, v16
  v_perm_b32 v57, v112, v112, v17
  v_perm_b32 v58, v112, v112, v18
  v_perm_b32 v59, v112, v112, v19
  s_nop 1
  v_mfma_f32_16x16x32_bf16 v[88:91], v[56:59], a[180:183], 0
  v_perm_b32 v60, v116, v116, v16
  v_perm_b32 v61, v116, v116, v17
  v_perm_b32 v62, v116, v116, v18
  v_perm_b32 v63, v116, v116, v19
  s_nop 1
  v_mfma_f32_16x16x32_bf16 v[92:95], v[60:63], a[180:183], 0
  v_perm_b32 v56, v113, v113, v16
  v_perm_b32 v57, v113, v113, v17
  v_perm_b32 v58, v113, v113, v18
  v_perm_b32 v59, v113, v113, v19
  s_nop 1
  v_mfma_f32_16x16x32_bf16 v[88:91], v[56:59], a[184:187], v[88:91]
  v_perm_b32 v60, v117, v117, v16
  v_perm_b32 v61, v117, v117, v17
  v_perm_b32 v62, v117, v117, v18
  v_perm_b32 v63, v117, v117, v19
  s_nop 1
  v_mfma_f32_16x16x32_bf16 v[92:95], v[60:63], a[184:187], v[92:95]
  v_perm_b32 v56, v114, v114, v16
  v_perm_b32 v57, v114, v114, v17
  v_perm_b32 v58, v114, v114, v18
  v_perm_b32 v59, v114, v114, v19
  s_nop 1
  v_mfma_f32_16x16x32_bf16 v[88:91], v[56:59], a[188:191], v[88:91]
  v_perm_b32 v60, v118, v118, v16
  v_perm_b32 v61, v118, v118, v17
  v_perm_b32 v62, v118, v118, v18
  v_perm_b32 v63, v118, v118, v19
  s_nop 1
  v_mfma_f32_16x16x32_bf16 v[92:95], v[60:63], a[188:191], v[92:95]
  v_perm_b32 v56, v115, v115, v16
  v_perm_b32 v57, v115, v115, v17
  v_perm_b32 v58, v115, v115, v18
  v_perm_b32 v59, v115, v115, v19
  s_nop 1
  v_mfma_f32_16x16x32_bf16 v[88:91], v[56:59], a[192:195], v[88:91]
  v_perm_b32 v60, v119, v119, v16
  v_perm_b32 v61, v119, v119, v17
  v_perm_b32 v62, v119, v119, v18
  v_perm_b32 v63, v119, v119, v19
  s_nop 1
  v_mfma_f32_16x16x32_bf16 v[92:95], v[60:63], a[192:195], v[92:95]
  v_perm_b32 v56, v128, v128, v16
  v_perm_b32 v57, v128, v128, v17
  v_perm_b32 v58, v128, v128, v18
  v_perm_b32 v59, v128, v128, v19
  s_nop 1
  v_mfma_f32_16x16x32_bf16 v[88:91], v[56:59], a[196:199], v[88:91]
  v_perm_b32 v60, v129, v129, v16
  v_perm_b32 v61, v129, v129, v17
  v_perm_b32 v62, v129, v129, v18
  v_perm_b32 v63, v129, v129, v19
  s_nop 1
  v_mfma_f32_16x16x32_bf16 v[92:95], v[60:63], a[196:199], v[92:95]
  v_mov_b32 v61, 0x3f803f80
  v_lshlrev_b32 v56, 16, v120
  v_and_b32 v57, 0xffff0000, v120
  v_lshlrev_b32 v58, 16, v124
  v_and_b32 v59, 0xffff0000, v124
  v_mul_f32 v56, v56, v58
  v_mul_f32 v57, v57, v59
  v_cvt_pk_bf16_f32 v60, v56, v57
  v_dot2_f32_bf16 v80, v60, v61, 0
  v_lshlrev_b32 v56, 16, v121
  v_and_b32 v57, 0xffff0000, v121
  v_lshlrev_b32 v58, 16, v125
  v_and_b32 v59, 0xffff0000, v125
  v_mul_f32 v56, v56, v58
  v_mul_f32 v57, v57, v59
  v_cvt_pk_bf16_f32 v60, v56, v57
  v_dot2_f32_bf16 v80, v60, v61, v80
  v_lshlrev_b32 v56, 16, v122
  v_and_b32 v57, 0xffff0000, v122
  v_lshlrev_b32 v58, 16, v126
  v_and_b32 v59, 0xffff0000, v126
  v_mul_f32 v56, v56, v58
  v_mul_f32 v57, v57, v59
  v_cvt_pk_bf16_f32 v60, v56, v57
  v_dot2_f32_bf16 v80, v60, v61, v80
  v_lshlrev_b32 v56, 16, v123
  v_and_b32 v57, 0xffff0000, v123
  v_lshlrev_b32 v58, 16, v127
  v_and_b32 v59, 0xffff0000, v127
  v_mul_f32 v56, v56, v58
  v_mul_f32 v57, v57, v59
  v_cvt_pk_bf16_f32 v60, v56, v57
  v_dot2_f32_bf16 v80, v60, v61, v80
  v_lshlrev_b32 v56, 16, v130
  v_and_b32 v57, 0xffff0000, v130
  v_lshlrev_b32 v58, 16, v131
  v_and_b32 v59, 0xffff0000, v131
  v_mul_f32 v56, v56, v58
  v_mul_f32 v57, v57, v59
  v_cvt_pk_bf16_f32 v60, v56, v57
  v_dot2_f32_bf16 v80, v60, v61, v80
  v_mov_b32_dpp v88, v88 row_ror:8 row_mask:0xc bank_mask:0x3
  v_mov_b32_dpp v89, v89 row_ror:8 row_mask:0xc bank_mask:0x3
  v_mov_b32_dpp v90, v90 row_ror:8 row_mask:0xc bank_mask:0x3
  v_mov_b32_dpp v91, v91 row_ror:8 row_mask:0xc bank_mask:0x3
  v_mov_b32_dpp v88, v92 row_ror:8 row_mask:0x3 bank_mask:0xc
  v_mov_b32_dpp v89, v93 row_ror:8 row_mask:0x3 bank_mask:0xc
  v_mov_b32_dpp v90, v94 row_ror:8 row_mask:0x3 bank_mask:0xc
  v_mov_b32_dpp v91, v95 row_ror:8 row_mask:0x3 bank_mask:0xc
  v_mov_b32_dpp v88, v92 quad_perm:[0,1,2,3] row_mask:0xc bank_mask:0xc
  v_mov_b32_dpp v89, v93 quad_perm:[0,1,2,3] row_mask:0xc bank_mask:0xc
  v_mov_b32_dpp v90, v94 quad_perm:[0,1,2,3] row_mask:0xc bank_mask:0xc
  v_mov_b32_dpp v91, v95 quad_perm:[0,1,2,3] row_mask:0xc bank_mask:0xc
  v_add_f32_dpp v80, v80, v80 quad_perm:[1,0,3,2] row_mask:0xf bank_mask:0xf
  s_nop 1
  v_add_f32_dpp v80, v80, v80 quad_perm:[2,3,0,1] row_mask:0xf bank_mask:0xf
  s_nop 1
  v_add_f32_dpp v80, v80, v80 row_half_mirror row_mask:0xf bank_mask:0xf
  s_nop 1
  v_add_f32_dpp v80, v80, v80 row_ror:8 row_mask:0xf bank_mask:0xf
  v_permlane32_swap_b32 v88, v90
  v_permlane32_swap_b32 v89, v91
  v_add_f32 v88, v88, v90
  v_add_f32 v89, v89, v91
  v_min_u32 v88, -2, v88
  v_min_u32 v89, -2, v89
  buffer_store_dwordx2 v[88:89], v1, s[76:79], 0 offen sc1
  v_mov_b32 v56, v80
  s_nop 1
  v_permlane16_swap_b32 v56, v80
  v_add_f32 v80, v80, v56
  v_mov_b32 v56, v80
  s_nop 1
  v_permlane32_swap_b32 v56, v80
  v_add_f32 v80, v80, v56
  v_cvt_pk_bf16_f32 v80, v80, v80
  v_lshlrev_b32 v80, 16, v80
  v_mul_f32 v80, 0xbfb8aa3b, v80
  v_exp_f32 v80, v80
  s_nop 0
  v_add_f32 v80, 1.0, v80
  v_rcp_f32 v80, v80
  s_nop 0
  v_cvt_pk_bf16_f32 v80, v80, v80
  v_lshlrev_b32 v80, 16, v80
  v_sub_f32 v87, 1.0, v80
  v_cvt_pk_bf16_f32 v87, v87, v87
  v_lshlrev_b32 v87, 16, v87
  s_waitcnt vmcnt(12)
  v_dot2_f32_bf16 v77, v168, v20, 0
  v_dot2_f32_bf16 v77, v169, v21, v77
  v_dot2_f32_bf16 v77, v170, v22, v77
  v_dot2_f32_bf16 v77, v171, v23, v77
  buffer_load_dwordx4 v[216:219], v9, s[44:47], s94 offen offset:1024 nt
  s_waitcnt vmcnt(12)
  v_dot2_f32_bf16 v78, v172, v20, 0
  v_dot2_f32_bf16 v78, v173, v21, v78
  v_dot2_f32_bf16 v78, v174, v22, v78
  v_dot2_f32_bf16 v78, v175, v23, v78
  buffer_load_dwordx4 v[220:223], v9, s[44:47], s94 offen offset:2048 nt
  s_mov_b32 s95, 0
  buffer_load_dwordx4 a[0:3], v10, s[56:59], s95 offen offset:0
  s_waitcnt vmcnt(13)
  v_dot2_f32_bf16 v79, v176, v20, 0
  v_dot2_f32_bf16 v79, v177, v21, v79
  v_dot2_f32_bf16 v79, v178, v22, v79
  v_dot2_f32_bf16 v79, v179, v23, v79
  buffer_load_dwordx4 v[224:227], v9, s[44:47], s94 offen offset:3072 nt
  v_add_f32_dpp v64, v64, v64 row_ror:8 row_mask:0xf bank_mask:0x3
  v_add_f32_dpp v65, v65, v65 row_ror:8 row_mask:0xf bank_mask:0x3
  v_add_f32_dpp v66, v66, v66 row_ror:8 row_mask:0xf bank_mask:0x3
  v_add_f32_dpp v67, v67, v67 row_ror:8 row_mask:0xf bank_mask:0x3
  v_add_f32_dpp v68, v68, v68 row_ror:8 row_mask:0xf bank_mask:0x3
  v_add_f32_dpp v69, v69, v69 row_ror:8 row_mask:0xf bank_mask:0x3
  v_add_f32_dpp v70, v70, v70 row_ror:8 row_mask:0xf bank_mask:0x3
  v_add_f32_dpp v71, v71, v71 row_ror:8 row_mask:0xf bank_mask:0x3
  v_add_f32_dpp v64, v72, v72 row_ror:8 row_mask:0xf bank_mask:0xc
  v_add_f32_dpp v65, v73, v73 row_ror:8 row_mask:0xf bank_mask:0xc
  v_add_f32_dpp v66, v74, v74 row_ror:8 row_mask:0xf bank_mask:0xc
  v_add_f32_dpp v67, v75, v75 row_ror:8 row_mask:0xf bank_mask:0xc
  v_add_f32_dpp v68, v76, v76 row_ror:8 row_mask:0xf bank_mask:0xc
  v_add_f32_dpp v69, v77, v77 row_ror:8 row_mask:0xf bank_mask:0xc
  v_add_f32_dpp v70, v78, v78 row_ror:8 row_mask:0xf bank_mask:0xc
  v_add_f32_dpp v71, v79, v79 row_ror:8 row_mask:0xf bank_mask:0xc
  v_add_f32_dpp v64, v64, v64 row_half_mirror row_mask:0xf bank_mask:0x5
  v_add_f32_dpp v65, v65, v65 row_half_mirror row_mask:0xf bank_mask:0x5
  v_add_f32_dpp v66, v66, v66 row_half_mirror row_mask:0xf bank_mask:0x5
  v_add_f32_dpp v67, v67, v67 row_half_mirror row_mask:0xf bank_mask:0x5
  v_add_f32_dpp v64, v68, v68 row_half_mirror row_mask:0xf bank_mask:0xa
  v_add_f32_dpp v65, v69, v69 row_half_mirror row_mask:0xf bank_mask:0xa
  v_add_f32_dpp v66, v70, v70 row_half_mirror row_mask:0xf bank_mask:0xa
  v_add_f32_dpp v67, v71, v71 row_half_mirror row_mask:0xf bank_mask:0xa
  v_cndmask_b32 v68, v66, v64, s[88:89]
  v_cndmask_b32 v69, v67, v65, s[88:89]
  v_cndmask_b32 v70, v64, v66, s[88:89]
  v_cndmask_b32 v71, v65, v67, s[88:89]
  v_add_f32_dpp v64, v68, v70 quad_perm:[2,3,0,1] row_mask:0xf bank_mask:0xf
  v_add_f32_dpp v65, v69, v71 quad_perm:[2,3,0,1] row_mask:0xf bank_mask:0xf
  v_cndmask_b32 v66, v65, v64, s[90:91]
  v_cndmask_b32 v67, v64, v65, s[90:91]
  s_nop 0
  v_add_f32_dpp v26, v66, v67 quad_perm:[1,0,3,2] row_mask:0xf bank_mask:0xf
  s_waitcnt vmcnt(13)
  v_dot2_f32_bf16 v64, v180, v20, 0
  v_dot2_f32_bf16 v64, v181, v21, v64
  v_dot2_f32_bf16 v64, v182, v22, v64
  v_dot2_f32_bf16 v64, v183, v23, v64
  s_xor_b32 s94, s23, 245760
  buffer_load_dwordx4 v[228:231], v9, s[44:47], s94 offen offset:0 nt
  s_waitcnt vmcnt(13)
  v_dot2_f32_bf16 v65, v184, v20, 0
  v_dot2_f32_bf16 v65, v185, v21, v65
  v_dot2_f32_bf16 v65, v186, v22, v65
  v_dot2_f32_bf16 v65, v187, v23, v65
  buffer_load_dwordx4 v[232:235], v9, s[44:47], s94 offen offset:1024 nt
  s_waitcnt vmcnt(13)
  v_dot2_f32_bf16 v66, v188, v20, 0
  v_dot2_f32_bf16 v66, v189, v21, v66
  v_dot2_f32_bf16 v66, v190, v22, v66
  v_dot2_f32_bf16 v66, v191, v23, v66
  buffer_load_dwordx4 v[236:239], v9, s[44:47], s94 offen offset:2048 nt
  buffer_load_dwordx4 a[4:7], v10, s[56:59], s95 offen offset:256
  s_waitcnt vmcnt(14)
  v_dot2_f32_bf16 v67, v192, v20, 0
  v_dot2_f32_bf16 v67, v193, v21, v67
  v_dot2_f32_bf16 v67, v194, v22, v67
  v_dot2_f32_bf16 v67, v195, v23, v67
  buffer_load_dwordx4 v[240:243], v9, s[44:47], s94 offen offset:3072 nt
  s_waitcnt vmcnt(14)
  v_dot2_f32_bf16 v68, v196, v20, 0
  v_dot2_f32_bf16 v68, v197, v21, v68
  v_dot2_f32_bf16 v68, v198, v22, v68
  v_dot2_f32_bf16 v68, v199, v23, v68
  s_xor_b32 s94, s23, 262144
  buffer_load_dwordx4 v[244:247], v9, s[44:47], s94 offen offset:0 nt
  s_waitcnt vmcnt(14)
  v_dot2_f32_bf16 v69, v200, v20, 0
  v_dot2_f32_bf16 v69, v201, v21, v69
  v_dot2_f32_bf16 v69, v202, v22, v69
  v_dot2_f32_bf16 v69, v203, v23, v69
  buffer_load_dwordx4 v[248:251], v9, s[44:47], s94 offen offset:1024 nt
  s_waitcnt vmcnt(14)
  v_dot2_f32_bf16 v70, v204, v20, 0
  v_dot2_f32_bf16 v70, v205, v21, v70
  v_dot2_f32_bf16 v70, v206, v22, v70
  v_dot2_f32_bf16 v70, v207, v23, v70
  buffer_load_dwordx4 v[252:255], v9, s[44:47], s94 offen offset:2048 nt
  buffer_load_dwordx4 a[8:11], v10, s[56:59], s95 offen offset:512
  s_waitcnt vmcnt(15)
  v_dot2_f32_bf16 v71, v208, v20, 0
  v_dot2_f32_bf16 v71, v209, v21, v71
  v_dot2_f32_bf16 v71, v210, v22, v71
  v_dot2_f32_bf16 v71, v211, v23, v71
  buffer_load_dwordx4 v[132:135], v9, s[44:47], s94 offen offset:3072 nt
  s_waitcnt vmcnt(15)
  v_dot2_f32_bf16 v72, v212, v20, 0
  v_dot2_f32_bf16 v72, v213, v21, v72
  v_dot2_f32_bf16 v72, v214, v22, v72
  v_dot2_f32_bf16 v72, v215, v23, v72
  s_xor_b32 s94, s23, 278528
  buffer_load_dwordx4 v[136:139], v9, s[44:47], s94 offen offset:0 nt
  s_waitcnt vmcnt(14)
  v_dot2_f32_bf16 v73, v216, v20, 0
  v_dot2_f32_bf16 v73, v217, v21, v73
  v_dot2_f32_bf16 v73, v218, v22, v73
  v_dot2_f32_bf16 v73, v219, v23, v73
  buffer_load_dwordx4 v[140:143], v9, s[44:47], s94 offen offset:1024 nt
  s_waitcnt vmcnt(14)
  v_dot2_f32_bf16 v74, v220, v20, 0
  v_dot2_f32_bf16 v74, v221, v21, v74
  v_dot2_f32_bf16 v74, v222, v22, v74
  v_dot2_f32_bf16 v74, v223, v23, v74
  buffer_load_dwordx4 v[144:147], v9, s[44:47], s94 offen offset:2048 nt
  buffer_load_dwordx4 a[12:15], v10, s[56:59], s95 offen offset:768
  s_waitcnt vmcnt(14)
  v_dot2_f32_bf16 v75, v224, v20, 0
  v_dot2_f32_bf16 v75, v225, v21, v75
  v_dot2_f32_bf16 v75, v226, v22, v75
  v_dot2_f32_bf16 v75, v227, v23, v75
  buffer_load_dwordx4 v[148:151], v9, s[44:47], s94 offen offset:3072 nt
  s_waitcnt vmcnt(14)
  v_dot2_f32_bf16 v76, v228, v20, 0
  v_dot2_f32_bf16 v76, v229, v21, v76
  v_dot2_f32_bf16 v76, v230, v22, v76
  v_dot2_f32_bf16 v76, v231, v23, v76
  s_xor_b32 s94, s23, 294912
  buffer_load_dwordx4 v[152:155], v9, s[44:47], s94 offen offset:0 nt
  s_waitcnt vmcnt(14)
  v_dot2_f32_bf16 v77, v232, v20, 0
  v_dot2_f32_bf16 v77, v233, v21, v77
  v_dot2_f32_bf16 v77, v234, v22, v77
  v_dot2_f32_bf16 v77, v235, v23, v77
  buffer_load_dwordx4 v[156:159], v9, s[44:47], s94 offen offset:1024 nt
  s_waitcnt vmcnt(14)
  v_dot2_f32_bf16 v78, v236, v20, 0
  v_dot2_f32_bf16 v78, v237, v21, v78
  v_dot2_f32_bf16 v78, v238, v22, v78
  v_dot2_f32_bf16 v78, v239, v23, v78
  buffer_load_dwordx4 v[160:163], v9, s[44:47], s94 offen offset:2048 nt
  buffer_load_dwordx4 a[16:19], v10, s[56:59], s95 offen offset:1024
  s_sub_u32 s8, s4, 27
  s_lshl_b32 s8, s8, 2
  s_add_u32 s8, s8, s6
  s_mul_i32 s9, s5, 20
  s_add_u32 s9, s9, s8
  s_lshl_b32 s10, s9, 14
  s_lshl_b32 s11, s3, 10
  s_add_u32 s10, s10, s11
  s_add_u32 s10, s10, 65536
  v_lshlrev_b32 v96, 4, v0
  v_add_u32 v96, s10, v96
  v_add_u32 v97, 4096, v96
  v_add_u32 v98, 8192, v96
  v_add_u32 v99, 12288, v96
  v_and_b32 v100, 7, v0
  v_lshlrev_b32 v100, 4, v100
  v_lshl_add_u32 v100, v2, 2, v100
  s_lshl_b32 s11, s3, 7
  v_add_u32 v100, s11, v100
  v_lshlrev_b32 v101, 3, v3
  s_lshl_b32 s9, s9, 6
  v_lshlrev_b32 v102, 2, v3
  v_add_u32 v102, s9, v102
  s_mov_b32 s0, -1
  s_mov_b32 s1, 0xff
  s_cmp_eq_u32 s3, 0
  s_cselect_b32 s26, 0xffff, 0
  s_mov_b32 s27, 0
  s_movk_i32 s30, 4096
  s_xor_b32 s31, s23, 16384
  s_waitcnt vmcnt(14)
  v_dot2_f32_bf16 v79, v240, v20, 0
  v_dot2_f32_bf16 v79, v241, v21, v79
  v_dot2_f32_bf16 v79, v242, v22, v79
  v_dot2_f32_bf16 v79, v243, v23, v79
  buffer_load_dwordx4 v[164:167], v9, s[44:47], s94 offen offset:3072 nt
  v_add_f32_dpp v64, v64, v64 row_ror:8 row_mask:0xf bank_mask:0x3
  v_add_f32_dpp v65, v65, v65 row_ror:8 row_mask:0xf bank_mask:0x3
  v_add_f32_dpp v66, v66, v66 row_ror:8 row_mask:0xf bank_mask:0x3
  v_add_f32_dpp v67, v67, v67 row_ror:8 row_mask:0xf bank_mask:0x3
  v_add_f32_dpp v68, v68, v68 row_ror:8 row_mask:0xf bank_mask:0x3
  v_add_f32_dpp v69, v69, v69 row_ror:8 row_mask:0xf bank_mask:0x3
  v_add_f32_dpp v70, v70, v70 row_ror:8 row_mask:0xf bank_mask:0x3
  v_add_f32_dpp v71, v71, v71 row_ror:8 row_mask:0xf bank_mask:0x3
  v_add_f32_dpp v64, v72, v72 row_ror:8 row_mask:0xf bank_mask:0xc
  v_add_f32_dpp v65, v73, v73 row_ror:8 row_mask:0xf bank_mask:0xc
  v_add_f32_dpp v66, v74, v74 row_ror:8 row_mask:0xf bank_mask:0xc
  v_add_f32_dpp v67, v75, v75 row_ror:8 row_mask:0xf bank_mask:0xc
  v_add_f32_dpp v68, v76, v76 row_ror:8 row_mask:0xf bank_mask:0xc
  v_add_f32_dpp v69, v77, v77 row_ror:8 row_mask:0xf bank_mask:0xc
  v_add_f32_dpp v70, v78, v78 row_ror:8 row_mask:0xf bank_mask:0xc
  v_add_f32_dpp v71, v79, v79 row_ror:8 row_mask:0xf bank_mask:0xc
  v_add_f32_dpp v64, v64, v64 row_half_mirror row_mask:0xf bank_mask:0x5
  v_add_f32_dpp v65, v65, v65 row_half_mirror row_mask:0xf bank_mask:0x5
  v_add_f32_dpp v66, v66, v66 row_half_mirror row_mask:0xf bank_mask:0x5
  v_add_f32_dpp v67, v67, v67 row_half_mirror row_mask:0xf bank_mask:0x5
  v_add_f32_dpp v64, v68, v68 row_half_mirror row_mask:0xf bank_mask:0xa
  v_add_f32_dpp v65, v69, v69 row_half_mirror row_mask:0xf bank_mask:0xa
  v_add_f32_dpp v66, v70, v70 row_half_mirror row_mask:0xf bank_mask:0xa
  v_add_f32_dpp v67, v71, v71 row_half_mirror row_mask:0xf bank_mask:0xa
  v_cndmask_b32 v68, v66, v64, s[88:89]
  v_cndmask_b32 v69, v67, v65, s[88:89]
  v_cndmask_b32 v70, v64, v66, s[88:89]
  v_cndmask_b32 v71, v65, v67, s[88:89]
  v_add_f32_dpp v64, v68, v70 quad_perm:[2,3,0,1] row_mask:0xf bank_mask:0xf
  v_add_f32_dpp v65, v69, v71 quad_perm:[2,3,0,1] row_mask:0xf bank_mask:0xf
  v_cndmask_b32 v66, v65, v64, s[90:91]
  v_cndmask_b32 v67, v64, v65, s[90:91]
  s_nop 0
  v_add_f32_dpp v27, v66, v67 quad_perm:[1,0,3,2] row_mask:0xf bank_mask:0xf
  v_cvt_pk_bf16_f32 v64, v26, v27
  v_lshlrev_b32 v26, 16, v64
  v_and_b32 v27, 0xffff0000, v64
  v_mul_f32 v26, 0x3db504f3, v26
  v_mul_f32 v27, 0x3db504f3, v27
  v_cvt_pk_bf16_f32 v64, v26, v27
  v_lshlrev_b32 v26, 16, v64
  v_and_b32 v27, 0xffff0000, v64
  s_waitcnt vmcnt(14)
  v_dot2_f32_bf16 v64, v244, v20, 0
  v_dot2_f32_bf16 v64, v245, v21, v64
  v_dot2_f32_bf16 v64, v246, v22, v64
  v_dot2_f32_bf16 v64, v247, v23, v64
  s_xor_b32 s94, s23, 311296
  buffer_load_dwordx4 v[112:115], v9, s[44:47], s94 offen offset:0 nt
  s_waitcnt vmcnt(14)
  v_dot2_f32_bf16 v65, v248, v20, 0
  v_dot2_f32_bf16 v65, v249, v21, v65
  v_dot2_f32_bf16 v65, v250, v22, v65
  v_dot2_f32_bf16 v65, v251, v23, v65
  buffer_load_dwordx4 v[116:119], v9, s[44:47], s94 offen offset:1024 nt
  s_waitcnt vmcnt(14)
  v_dot2_f32_bf16 v66, v252, v20, 0
  v_dot2_f32_bf16 v66, v253, v21, v66
  v_dot2_f32_bf16 v66, v254, v22, v66
  v_dot2_f32_bf16 v66, v255, v23, v66
  buffer_load_dwordx4 v[120:123], v9, s[44:47], s94 offen offset:2048 nt
  buffer_load_dwordx4 a[20:23], v10, s[56:59], s95 offen offset:1280
  s_waitcnt vmcnt(14)
  v_dot2_f32_bf16 v67, v132, v20, 0
  v_dot2_f32_bf16 v67, v133, v21, v67
  v_dot2_f32_bf16 v67, v134, v22, v67
  v_dot2_f32_bf16 v67, v135, v23, v67
  buffer_load_dwordx4 v[124:127], v9, s[44:47], s94 offen offset:3072 nt
  s_waitcnt vmcnt(14)
  v_dot2_f32_bf16 v68, v136, v20, 0
  v_dot2_f32_bf16 v68, v137, v21, v68
  v_dot2_f32_bf16 v68, v138, v22, v68
  v_dot2_f32_bf16 v68, v139, v23, v68
  s_xor_b32 s94, s23, 327680
  buffer_load_dwordx4 v[128:131], v9, s[44:47], s94 offen offset:0 nt
  s_waitcnt vmcnt(14)
  v_dot2_f32_bf16 v69, v140, v20, 0
  v_dot2_f32_bf16 v69, v141, v21, v69
  v_dot2_f32_bf16 v69, v142, v22, v69
  v_dot2_f32_bf16 v69, v143, v23, v69
  buffer_load_dwordx4 v[168:171], v9, s[44:47], s94 offen offset:1024 nt
  s_waitcnt vmcnt(14)
  v_dot2_f32_bf16 v70, v144, v20, 0
  v_dot2_f32_bf16 v70, v145, v21, v70
  v_dot2_f32_bf16 v70, v146, v22, v70
  v_dot2_f32_bf16 v70, v147, v23, v70
  buffer_load_dwordx4 v[172:175], v9, s[44:47], s94 offen offset:2048 nt
  buffer_load_dwordx4 a[24:27], v10, s[56:59], s95 offen offset:1536
  s_waitcnt vmcnt(14)
  v_dot2_f32_bf16 v71, v148, v20, 0
  v_dot2_f32_bf16 v71, v149, v21, v71
  v_dot2_f32_bf16 v71, v150, v22, v71
  v_dot2_f32_bf16 v71, v151, v23, v71
  buffer_load_dwordx4 v[176:179], v9, s[44:47], s94 offen offset:3072 nt
  s_waitcnt vmcnt(14)
  v_dot2_f32_bf16 v72, v152, v20, 0
  v_dot2_f32_bf16 v72, v153, v21, v72
  v_dot2_f32_bf16 v72, v154, v22, v72
  v_dot2_f32_bf16 v72, v155, v23, v72
  s_xor_b32 s94, s23, 344064
  buffer_load_dwordx4 v[180:183], v9, s[44:47], s94 offen offset:0 nt
  s_waitcnt vmcnt(14)
  v_dot2_f32_bf16 v73, v156, v20, 0
  v_dot2_f32_bf16 v73, v157, v21, v73
  v_dot2_f32_bf16 v73, v158, v22, v73
  v_dot2_f32_bf16 v73, v159, v23, v73
  buffer_load_dwordx4 v[184:187], v9, s[44:47], s94 offen offset:1024 nt
  s_waitcnt vmcnt(14)
  v_dot2_f32_bf16 v74, v160, v20, 0
  v_dot2_f32_bf16 v74, v161, v21, v74
  v_dot2_f32_bf16 v74, v162, v22, v74
  v_dot2_f32_bf16 v74, v163, v23, v74
  buffer_load_dwordx4 v[188:191], v9, s[44:47], s94 offen offset:2048 nt
  buffer_load_dwordx4 a[28:31], v10, s[56:59], s95 offen offset:1792
  s_waitcnt vmcnt(14)
  v_dot2_f32_bf16 v75, v164, v20, 0
  v_dot2_f32_bf16 v75, v165, v21, v75
  v_dot2_f32_bf16 v75, v166, v22, v75
  v_dot2_f32_bf16 v75, v167, v23, v75
  buffer_load_dwordx4 v[192:195], v9, s[44:47], s94 offen offset:3072 nt
  s_waitcnt vmcnt(14)
  v_dot2_f32_bf16 v76, v112, v20, 0
  v_dot2_f32_bf16 v76, v113, v21, v76
  v_dot2_f32_bf16 v76, v114, v22, v76
  v_dot2_f32_bf16 v76, v115, v23, v76
  s_xor_b32 s94, s23, 360448
  buffer_load_dwordx4 v[196:199], v9, s[44:47], s94 offen offset:0 nt
  s_waitcnt vmcnt(14)
  v_dot2_f32_bf16 v77, v116, v20, 0
  v_dot2_f32_bf16 v77, v117, v21, v77
  v_dot2_f32_bf16 v77, v118, v22, v77
  v_dot2_f32_bf16 v77, v119, v23, v77
  buffer_load_dwordx4 v[200:203], v9, s[44:47], s94 offen offset:1024 nt
  s_waitcnt vmcnt(14)
  v_dot2_f32_bf16 v78, v120, v20, 0
  v_dot2_f32_bf16 v78, v121, v21, v78
  v_dot2_f32_bf16 v78, v122, v22, v78
  v_dot2_f32_bf16 v78, v123, v23, v78
  buffer_load_dwordx4 v[204:207], v9, s[44:47], s94 offen offset:2048 nt
  buffer_load_dwordx4 a[32:35], v10, s[56:59], s95 offen offset:2048
  s_waitcnt vmcnt(14)
  v_dot2_f32_bf16 v79, v124, v20, 0
  v_dot2_f32_bf16 v79, v125, v21, v79
  v_dot2_f32_bf16 v79, v126, v22, v79
  v_dot2_f32_bf16 v79, v127, v23, v79
  buffer_load_dwordx4 v[208:211], v9, s[44:47], s94 offen offset:3072 nt
  v_add_f32_dpp v64, v64, v64 row_ror:8 row_mask:0xf bank_mask:0x3
  v_add_f32_dpp v65, v65, v65 row_ror:8 row_mask:0xf bank_mask:0x3
  v_add_f32_dpp v66, v66, v66 row_ror:8 row_mask:0xf bank_mask:0x3
  v_add_f32_dpp v67, v67, v67 row_ror:8 row_mask:0xf bank_mask:0x3
  v_add_f32_dpp v68, v68, v68 row_ror:8 row_mask:0xf bank_mask:0x3
  v_add_f32_dpp v69, v69, v69 row_ror:8 row_mask:0xf bank_mask:0x3
  v_add_f32_dpp v70, v70, v70 row_ror:8 row_mask:0xf bank_mask:0x3
  v_add_f32_dpp v71, v71, v71 row_ror:8 row_mask:0xf bank_mask:0x3
  v_add_f32_dpp v64, v72, v72 row_ror:8 row_mask:0xf bank_mask:0xc
  v_add_f32_dpp v65, v73, v73 row_ror:8 row_mask:0xf bank_mask:0xc
  v_add_f32_dpp v66, v74, v74 row_ror:8 row_mask:0xf bank_mask:0xc
  v_add_f32_dpp v67, v75, v75 row_ror:8 row_mask:0xf bank_mask:0xc
  v_add_f32_dpp v68, v76, v76 row_ror:8 row_mask:0xf bank_mask:0xc
  v_add_f32_dpp v69, v77, v77 row_ror:8 row_mask:0xf bank_mask:0xc
  v_add_f32_dpp v70, v78, v78 row_ror:8 row_mask:0xf bank_mask:0xc
  v_add_f32_dpp v71, v79, v79 row_ror:8 row_mask:0xf bank_mask:0xc
  v_add_f32_dpp v64, v64, v64 row_half_mirror row_mask:0xf bank_mask:0x5
  v_add_f32_dpp v65, v65, v65 row_half_mirror row_mask:0xf bank_mask:0x5
  v_add_f32_dpp v66, v66, v66 row_half_mirror row_mask:0xf bank_mask:0x5
  v_add_f32_dpp v67, v67, v67 row_half_mirror row_mask:0xf bank_mask:0x5
  v_add_f32_dpp v64, v68, v68 row_half_mirror row_mask:0xf bank_mask:0xa
  v_add_f32_dpp v65, v69, v69 row_half_mirror row_mask:0xf bank_mask:0xa
  v_add_f32_dpp v66, v70, v70 row_half_mirror row_mask:0xf bank_mask:0xa
  v_add_f32_dpp v67, v71, v71 row_half_mirror row_mask:0xf bank_mask:0xa
  v_cndmask_b32 v68, v66, v64, s[88:89]
  v_cndmask_b32 v69, v67, v65, s[88:89]
  v_cndmask_b32 v70, v64, v66, s[88:89]
  v_cndmask_b32 v71, v65, v67, s[88:89]
  v_add_f32_dpp v64, v68, v70 quad_perm:[2,3,0,1] row_mask:0xf bank_mask:0xf
  v_add_f32_dpp v65, v69, v71 quad_perm:[2,3,0,1] row_mask:0xf bank_mask:0xf
  v_cndmask_b32 v66, v65, v64, s[90:91]
  v_cndmask_b32 v67, v64, v65, s[90:91]
  s_nop 0
  v_add_f32_dpp v28, v66, v67 quad_perm:[1,0,3,2] row_mask:0xf bank_mask:0xf
  s_waitcnt vmcnt(14)
  v_dot2_f32_bf16 v64, v128, v20, 0
  v_dot2_f32_bf16 v64, v129, v21, v64
  v_dot2_f32_bf16 v64, v130, v22, v64
  v_dot2_f32_bf16 v64, v131, v23, v64
  s_xor_b32 s94, s23, 376832
  buffer_load_dwordx4 v[212:215], v9, s[44:47], s94 offen offset:0 nt
  s_waitcnt vmcnt(14)
  v_dot2_f32_bf16 v65, v168, v20, 0
  v_dot2_f32_bf16 v65, v169, v21, v65
  v_dot2_f32_bf16 v65, v170, v22, v65
  v_dot2_f32_bf16 v65, v171, v23, v65
  buffer_load_dwordx4 v[216:219], v9, s[44:47], s94 offen offset:1024 nt
  s_waitcnt vmcnt(14)
  v_dot2_f32_bf16 v66, v172, v20, 0
  v_dot2_f32_bf16 v66, v173, v21, v66
  v_dot2_f32_bf16 v66, v174, v22, v66
  v_dot2_f32_bf16 v66, v175, v23, v66
  buffer_load_dwordx4 v[220:223], v9, s[44:47], s94 offen offset:2048 nt
  buffer_load_dwordx4 a[36:39], v10, s[56:59], s95 offen offset:2304
  s_waitcnt vmcnt(14)
  v_dot2_f32_bf16 v67, v176, v20, 0
  v_dot2_f32_bf16 v67, v177, v21, v67
  v_dot2_f32_bf16 v67, v178, v22, v67
  v_dot2_f32_bf16 v67, v179, v23, v67
  buffer_load_dwordx4 v[224:227], v9, s[44:47], s94 offen offset:3072 nt
  s_waitcnt vmcnt(14)
  v_dot2_f32_bf16 v68, v180, v20, 0
  v_dot2_f32_bf16 v68, v181, v21, v68
  v_dot2_f32_bf16 v68, v182, v22, v68
  v_dot2_f32_bf16 v68, v183, v23, v68
  s_xor_b32 s94, s23, 393216
  buffer_load_dwordx4 v[228:231], v9, s[44:47], s94 offen offset:0 nt
  s_waitcnt vmcnt(14)
  v_dot2_f32_bf16 v69, v184, v20, 0
  v_dot2_f32_bf16 v69, v185, v21, v69
  v_dot2_f32_bf16 v69, v186, v22, v69
  v_dot2_f32_bf16 v69, v187, v23, v69
  buffer_load_dwordx4 v[232:235], v9, s[44:47], s94 offen offset:1024 nt
  s_waitcnt vmcnt(14)
  v_dot2_f32_bf16 v70, v188, v20, 0
  v_dot2_f32_bf16 v70, v189, v21, v70
  v_dot2_f32_bf16 v70, v190, v22, v70
  v_dot2_f32_bf16 v70, v191, v23, v70
  buffer_load_dwordx4 v[236:239], v9, s[44:47], s94 offen offset:2048 nt
  buffer_load_dwordx4 a[40:43], v10, s[56:59], s95 offen offset:2560
  s_waitcnt vmcnt(14)
  v_dot2_f32_bf16 v71, v192, v20, 0
  v_dot2_f32_bf16 v71, v193, v21, v71
  v_dot2_f32_bf16 v71, v194, v22, v71
  v_dot2_f32_bf16 v71, v195, v23, v71
  buffer_load_dwordx4 v[240:243], v9, s[44:47], s94 offen offset:3072 nt
  s_waitcnt vmcnt(14)
  v_dot2_f32_bf16 v72, v196, v20, 0
  v_dot2_f32_bf16 v72, v197, v21, v72
  v_dot2_f32_bf16 v72, v198, v22, v72
  v_dot2_f32_bf16 v72, v199, v23, v72
  s_xor_b32 s94, s23, 409600
  buffer_load_dwordx4 v[244:247], v9, s[44:47], s94 offen offset:0 nt
  s_waitcnt vmcnt(14)
  v_dot2_f32_bf16 v73, v200, v20, 0
  v_dot2_f32_bf16 v73, v201, v21, v73
  v_dot2_f32_bf16 v73, v202, v22, v73
  v_dot2_f32_bf16 v73, v203, v23, v73
  buffer_load_dwordx4 v[248:251], v9, s[44:47], s94 offen offset:1024 nt
  s_waitcnt vmcnt(14)
  v_dot2_f32_bf16 v74, v204, v20, 0
  v_dot2_f32_bf16 v74, v205, v21, v74
  v_dot2_f32_bf16 v74, v206, v22, v74
  v_dot2_f32_bf16 v74, v207, v23, v74
  buffer_load_dwordx4 v[252:255], v9, s[44:47], s94 offen offset:2048 nt
  buffer_load_dwordx4 a[44:47], v10, s[56:59], s95 offen offset:2816
  s_cmp_eq_u32 s3, 0
  s_cbranch_scc0 L_w0_ci
  buffer_load_dword v94, v86, s[80:83], 0 offen sc1
L_w0_ci:
  s_waitcnt vmcnt(14)
  v_dot2_f32_bf16 v75, v208, v20, 0
  v_dot2_f32_bf16 v75, v209, v21, v75
  v_dot2_f32_bf16 v75, v210, v22, v75
  v_dot2_f32_bf16 v75, v211, v23, v75
  buffer_load_dwordx4 v[132:135], v9, s[44:47], s94 offen offset:3072 nt
  s_waitcnt vmcnt(14)
  v_dot2_f32_bf16 v76, v212, v20, 0
  v_dot2_f32_bf16 v76, v213, v21, v76
  v_dot2_f32_bf16 v76, v214, v22, v76
  v_dot2_f32_bf16 v76, v215, v23, v76
  s_xor_b32 s94, s23, 425984
  buffer_load_dwordx4 v[136:139], v9, s[44:47], s94 offen offset:0 nt
  s_waitcnt vmcnt(14)
  v_dot2_f32_bf16 v77, v216, v20, 0
  v_dot2_f32_bf16 v77, v217, v21, v77
  v_dot2_f32_bf16 v77, v218, v22, v77
  v_dot2_f32_bf16 v77, v219, v23, v77
  buffer_load_dwordx4 v[140:143], v9, s[44:47], s94 offen offset:1024 nt
  s_waitcnt vmcnt(14)
  v_dot2_f32_bf16 v78, v220, v20, 0
  v_dot2_f32_bf16 v78, v221, v21, v78
  v_dot2_f32_bf16 v78, v222, v22, v78
  v_dot2_f32_bf16 v78, v223, v23, v78
  buffer_load_dwordx4 v[144:147], v9, s[44:47], s94 offen offset:2048 nt
  buffer_load_dwordx4 a[48:51], v10, s[56:59], s95 offen offset:3072
  s_waitcnt vmcnt(14)
  v_dot2_f32_bf16 v79, v224, v20, 0
  v_dot2_f32_bf16 v79, v225, v21, v79
  v_dot2_f32_bf16 v79, v226, v22, v79
  v_dot2_f32_bf16 v79, v227, v23, v79
  buffer_load_dwordx4 v[148:151], v9, s[44:47], s94 offen offset:3072 nt
  v_add_f32_dpp v64, v64, v64 row_ror:8 row_mask:0xf bank_mask:0x3
  v_add_f32_dpp v65, v65, v65 row_ror:8 row_mask:0xf bank_mask:0x3
  v_add_f32_dpp v66, v66, v66 row_ror:8 row_mask:0xf bank_mask:0x3
  v_add_f32_dpp v67, v67, v67 row_ror:8 row_mask:0xf bank_mask:0x3
  v_add_f32_dpp v68, v68, v68 row_ror:8 row_mask:0xf bank_mask:0x3
  v_add_f32_dpp v69, v69, v69 row_ror:8 row_mask:0xf bank_mask:0x3
  v_add_f32_dpp v70, v70, v70 row_ror:8 row_mask:0xf bank_mask:0x3
  v_add_f32_dpp v71, v71, v71 row_ror:8 row_mask:0xf bank_mask:0x3
  v_add_f32_dpp v64, v72, v72 row_ror:8 row_mask:0xf bank_mask:0xc
  v_add_f32_dpp v65, v73, v73 row_ror:8 row_mask:0xf bank_mask:0xc
  v_add_f32_dpp v66, v74, v74 row_ror:8 row_mask:0xf bank_mask:0xc
  v_add_f32_dpp v67, v75, v75 row_ror:8 row_mask:0xf bank_mask:0xc
  v_add_f32_dpp v68, v76, v76 row_ror:8 row_mask:0xf bank_mask:0xc
  v_add_f32_dpp v69, v77, v77 row_ror:8 row_mask:0xf bank_mask:0xc
  v_add_f32_dpp v70, v78, v78 row_ror:8 row_mask:0xf bank_mask:0xc
  v_add_f32_dpp v71, v79, v79 row_ror:8 row_mask:0xf bank_mask:0xc
  v_add_f32_dpp v64, v64, v64 row_half_mirror row_mask:0xf bank_mask:0x5
  v_add_f32_dpp v65, v65, v65 row_half_mirror row_mask:0xf bank_mask:0x5
  v_add_f32_dpp v66, v66, v66 row_half_mirror row_mask:0xf bank_mask:0x5
  v_add_f32_dpp v67, v67, v67 row_half_mirror row_mask:0xf bank_mask:0x5
  v_add_f32_dpp v64, v68, v68 row_half_mirror row_mask:0xf bank_mask:0xa
  v_add_f32_dpp v65, v69, v69 row_half_mirror row_mask:0xf bank_mask:0xa
  v_add_f32_dpp v66, v70, v70 row_half_mirror row_mask:0xf bank_mask:0xa
  v_add_f32_dpp v67, v71, v71 row_half_mirror row_mask:0xf bank_mask:0xa
  v_cndmask_b32 v68, v66, v64, s[88:89]
  v_cndmask_b32 v69, v67, v65, s[88:89]
  v_cndmask_b32 v70, v64, v66, s[88:89]
  v_cndmask_b32 v71, v65, v67, s[88:89]
  v_add_f32_dpp v64, v68, v70 quad_perm:[2,3,0,1] row_mask:0xf bank_mask:0xf
  v_add_f32_dpp v65, v69, v71 quad_perm:[2,3,0,1] row_mask:0xf bank_mask:0xf
  v_cndmask_b32 v66, v65, v64, s[90:91]
  v_cndmask_b32 v67, v64, v65, s[90:91]
  s_nop 0
  v_add_f32_dpp v29, v66, v67 quad_perm:[1,0,3,2] row_mask:0xf bank_mask:0xf
  v_cvt_pk_bf16_f32 v64, v28, v29
  v_lshlrev_b32 v28, 16, v64
  v_and_b32 v29, 0xffff0000, v64
  v_mul_f32 v28, 0x3db504f3, v28
  v_mul_f32 v29, 0x3db504f3, v29
  v_cvt_pk_bf16_f32 v64, v28, v29
  v_lshlrev_b32 v28, 16, v64
  v_and_b32 v29, 0xffff0000, v64
  s_waitcnt vmcnt(14)
  v_dot2_f32_bf16 v64, v228, v20, 0
  v_dot2_f32_bf16 v64, v229, v21, v64
  v_dot2_f32_bf16 v64, v230, v22, v64
  v_dot2_f32_bf16 v64, v231, v23, v64
  s_xor_b32 s94, s23, 442368
  buffer_load_dwordx4 v[152:155], v9, s[44:47], s94 offen offset:0 nt
  s_waitcnt vmcnt(14)
  v_dot2_f32_bf16 v65, v232, v20, 0
  v_dot2_f32_bf16 v65, v233, v21, v65
  v_dot2_f32_bf16 v65, v234, v22, v65
  v_dot2_f32_bf16 v65, v235, v23, v65
  buffer_load_dwordx4 v[156:159], v9, s[44:47], s94 offen offset:1024 nt
  s_waitcnt vmcnt(14)
  v_dot2_f32_bf16 v66, v236, v20, 0
  v_dot2_f32_bf16 v66, v237, v21, v66
  v_dot2_f32_bf16 v66, v238, v22, v66
  v_dot2_f32_bf16 v66, v239, v23, v66
  buffer_load_dwordx4 v[160:163], v9, s[44:47], s94 offen offset:2048 nt
  buffer_load_dwordx4 a[52:55], v10, s[56:59], s95 offen offset:3328
  s_waitcnt vmcnt(14)
  v_dot2_f32_bf16 v67, v240, v20, 0
  v_dot2_f32_bf16 v67, v241, v21, v67
  v_dot2_f32_bf16 v67, v242, v22, v67
  v_dot2_f32_bf16 v67, v243, v23, v67
  buffer_load_dwordx4 v[164:167], v9, s[44:47], s94 offen offset:3072 nt
  s_waitcnt vmcnt(14)
  v_dot2_f32_bf16 v68, v244, v20, 0
  v_dot2_f32_bf16 v68, v245, v21, v68
  v_dot2_f32_bf16 v68, v246, v22, v68
  v_dot2_f32_bf16 v68, v247, v23, v68
  s_xor_b32 s94, s23, 458752
  buffer_load_dwordx4 v[112:115], v9, s[44:47], s94 offen offset:0 nt
  s_waitcnt vmcnt(14)
  v_dot2_f32_bf16 v69, v248, v20, 0
  v_dot2_f32_bf16 v69, v249, v21, v69
  v_dot2_f32_bf16 v69, v250, v22, v69
  v_dot2_f32_bf16 v69, v251, v23, v69
  buffer_load_dwordx4 v[116:119], v9, s[44:47], s94 offen offset:1024 nt
  s_waitcnt vmcnt(14)
  v_dot2_f32_bf16 v70, v252, v20, 0
  v_dot2_f32_bf16 v70, v253, v21, v70
  v_dot2_f32_bf16 v70, v254, v22, v70
  v_dot2_f32_bf16 v70, v255, v23, v70
  buffer_load_dwordx4 v[120:123], v9, s[44:47], s94 offen offset:2048 nt
  buffer_load_dwordx4 a[56:59], v10, s[56:59], s95 offen offset:3584
  s_waitcnt vmcnt(14)
  v_dot2_f32_bf16 v71, v132, v20, 0
  v_dot2_f32_bf16 v71, v133, v21, v71
  v_dot2_f32_bf16 v71, v134, v22, v71
  v_dot2_f32_bf16 v71, v135, v23, v71
  buffer_load_dwordx4 v[124:127], v9, s[44:47], s94 offen offset:3072 nt
  s_waitcnt vmcnt(14)
  v_dot2_f32_bf16 v72, v136, v20, 0
  v_dot2_f32_bf16 v72, v137, v21, v72
  v_dot2_f32_bf16 v72, v138, v22, v72
  v_dot2_f32_bf16 v72, v139, v23, v72
  s_xor_b32 s94, s23, 475136
  buffer_load_dwordx4 v[128:131], v9, s[44:47], s94 offen offset:0 nt
  s_waitcnt vmcnt(14)
  v_dot2_f32_bf16 v73, v140, v20, 0
  v_dot2_f32_bf16 v73, v141, v21, v73
  v_dot2_f32_bf16 v73, v142, v22, v73
  v_dot2_f32_bf16 v73, v143, v23, v73
  buffer_load_dwordx4 v[168:171], v9, s[44:47], s94 offen offset:1024 nt
  s_waitcnt vmcnt(14)
  v_dot2_f32_bf16 v74, v144, v20, 0
  v_dot2_f32_bf16 v74, v145, v21, v74
  v_dot2_f32_bf16 v74, v146, v22, v74
  v_dot2_f32_bf16 v74, v147, v23, v74
  buffer_load_dwordx4 v[172:175], v9, s[44:47], s94 offen offset:2048 nt
  s_mov_b32 s95, 3840
  buffer_load_dwordx4 a[60:63], v10, s[56:59], s95 offen offset:0
  s_waitcnt vmcnt(14)
  v_dot2_f32_bf16 v75, v148, v20, 0
  v_dot2_f32_bf16 v75, v149, v21, v75
  v_dot2_f32_bf16 v75, v150, v22, v75
  v_dot2_f32_bf16 v75, v151, v23, v75
  buffer_load_dwordx4 v[176:179], v9, s[44:47], s94 offen offset:3072 nt
  s_waitcnt vmcnt(14)
  v_dot2_f32_bf16 v76, v152, v20, 0
  v_dot2_f32_bf16 v76, v153, v21, v76
  v_dot2_f32_bf16 v76, v154, v22, v76
  v_dot2_f32_bf16 v76, v155, v23, v76
  s_xor_b32 s94, s23, 491520
  buffer_load_dwordx4 v[180:183], v9, s[44:47], s94 offen offset:0 nt
  s_waitcnt vmcnt(14)
  v_dot2_f32_bf16 v77, v156, v20, 0
  v_dot2_f32_bf16 v77, v157, v21, v77
  v_dot2_f32_bf16 v77, v158, v22, v77
  v_dot2_f32_bf16 v77, v159, v23, v77
  buffer_load_dwordx4 v[184:187], v9, s[44:47], s94 offen offset:1024 nt
  s_waitcnt vmcnt(14)
  v_dot2_f32_bf16 v78, v160, v20, 0
  v_dot2_f32_bf16 v78, v161, v21, v78
  v_dot2_f32_bf16 v78, v162, v22, v78
  v_dot2_f32_bf16 v78, v163, v23, v78
  buffer_load_dwordx4 v[188:191], v9, s[44:47], s94 offen offset:2048 nt
  buffer_load_dwordx4 a[64:67], v10, s[56:59], s95 offen offset:256
  s_cmp_eq_u32 s3, 0
  s_cbranch_scc0 L_w0_cu
  v_cmp_gt_u32 vcc, 4, v94
  s_nop 0
  s_cmp_eq_u64 vcc, 0
  s_cbranch_scc0 L_slow_cnt
L_ok_cnt:
L_w0_cu:
  s_waitcnt vmcnt(14)
  v_dot2_f32_bf16 v79, v164, v20, 0
  v_dot2_f32_bf16 v79, v165, v21, v79
  v_dot2_f32_bf16 v79, v166, v22, v79
  v_dot2_f32_bf16 v79, v167, v23, v79
  buffer_load_dwordx4 v[192:195], v9, s[44:47], s94 offen offset:3072 nt
  v_add_f32_dpp v64, v64, v64 row_ror:8 row_mask:0xf bank_mask:0x3
  v_add_f32_dpp v65, v65, v65 row_ror:8 row_mask:0xf bank_mask:0x3
  v_add_f32_dpp v66, v66, v66 row_ror:8 row_mask:0xf bank_mask:0x3
  v_add_f32_dpp v67, v67, v67 row_ror:8 row_mask:0xf bank_mask:0x3
  v_add_f32_dpp v68, v68, v68 row_ror:8 row_mask:0xf bank_mask:0x3
  v_add_f32_dpp v69, v69, v69 row_ror:8 row_mask:0xf bank_mask:0x3
  v_add_f32_dpp v70, v70, v70 row_ror:8 row_mask:0xf bank_mask:0x3
  v_add_f32_dpp v71, v71, v71 row_ror:8 row_mask:0xf bank_mask:0x3
  v_add_f32_dpp v64, v72, v72 row_ror:8 row_mask:0xf bank_mask:0xc
  v_add_f32_dpp v65, v73, v73 row_ror:8 row_mask:0xf bank_mask:0xc
  v_add_f32_dpp v66, v74, v74 row_ror:8 row_mask:0xf bank_mask:0xc
  v_add_f32_dpp v67, v75, v75 row_ror:8 row_mask:0xf bank_mask:0xc
  v_add_f32_dpp v68, v76, v76 row_ror:8 row_mask:0xf bank_mask:0xc
  v_add_f32_dpp v69, v77, v77 row_ror:8 row_mask:0xf bank_mask:0xc
  v_add_f32_dpp v70, v78, v78 row_ror:8 row_mask:0xf bank_mask:0xc
  v_add_f32_dpp v71, v79, v79 row_ror:8 row_mask:0xf bank_mask:0xc
  v_add_f32_dpp v64, v64, v64 row_half_mirror row_mask:0xf bank_mask:0x5
  v_add_f32_dpp v65, v65, v65 row_half_mirror row_mask:0xf bank_mask:0x5
  v_add_f32_dpp v66, v66, v66 row_half_mirror row_mask:0xf bank_mask:0x5
  v_add_f32_dpp v67, v67, v67 row_half_mirror row_mask:0xf bank_mask:0x5
  v_add_f32_dpp v64, v68, v68 row_half_mirror row_mask:0xf bank_mask:0xa
  v_add_f32_dpp v65, v69, v69 row_half_mirror row_mask:0xf bank_mask:0xa
  v_add_f32_dpp v66, v70, v70 row_half_mirror row_mask:0xf bank_mask:0xa
  v_add_f32_dpp v67, v71, v71 row_half_mirror row_mask:0xf bank_mask:0xa
  v_cndmask_b32 v68, v66, v64, s[88:89]
  v_cndmask_b32 v69, v67, v65, s[88:89]
  v_cndmask_b32 v70, v64, v66, s[88:89]
  v_cndmask_b32 v71, v65, v67, s[88:89]
  v_add_f32_dpp v64, v68, v70 quad_perm:[2,3,0,1] row_mask:0xf bank_mask:0xf
  v_add_f32_dpp v65, v69, v71 quad_perm:[2,3,0,1] row_mask:0xf bank_mask:0xf
  v_cndmask_b32 v66, v65, v64, s[90:91]
  v_cndmask_b32 v67, v64, v65, s[90:91]
  s_nop 0
  v_add_f32_dpp v30, v66, v67 quad_perm:[1,0,3,2] row_mask:0xf bank_mask:0xf
  s_waitcnt vmcnt(14)
  v_dot2_f32_bf16 v64, v112, v20, 0
  v_dot2_f32_bf16 v64, v113, v21, v64
  v_dot2_f32_bf16 v64, v114, v22, v64
  v_dot2_f32_bf16 v64, v115, v23, v64
  s_xor_b32 s94, s23, 507904
  buffer_load_dwordx4 v[196:199], v9, s[44:47], s94 offen offset:0 nt
  s_waitcnt vmcnt(14)
  v_dot2_f32_bf16 v65, v116, v20, 0
  v_dot2_f32_bf16 v65, v117, v21, v65
  v_dot2_f32_bf16 v65, v118, v22, v65
  v_dot2_f32_bf16 v65, v119, v23, v65
  buffer_load_dwordx4 v[200:203], v9, s[44:47], s94 offen offset:1024 nt
  s_waitcnt vmcnt(14)
  v_dot2_f32_bf16 v66, v120, v20, 0
  v_dot2_f32_bf16 v66, v121, v21, v66
  v_dot2_f32_bf16 v66, v122, v22, v66
  v_dot2_f32_bf16 v66, v123, v23, v66
  buffer_load_dwordx4 v[204:207], v9, s[44:47], s94 offen offset:2048 nt
  buffer_load_dwordx4 a[68:71], v10, s[56:59], s95 offen offset:512
  s_waitcnt vmcnt(14)
  v_dot2_f32_bf16 v67, v124, v20, 0
  v_dot2_f32_bf16 v67, v125, v21, v67
  v_dot2_f32_bf16 v67, v126, v22, v67
  v_dot2_f32_bf16 v67, v127, v23, v67
  buffer_load_dwordx4 v[208:211], v9, s[44:47], s94 offen offset:3072 nt
  s_waitcnt vmcnt(14)
  v_dot2_f32_bf16 v68, v128, v20, 0
  v_dot2_f32_bf16 v68, v129, v21, v68
  v_dot2_f32_bf16 v68, v130, v22, v68
  v_dot2_f32_bf16 v68, v131, v23, v68
  s_xor_b32 s94, s23, 0
  buffer_load_dwordx4 v[212:215], v9, s[48:51], s94 offen offset:0 nt
  s_waitcnt vmcnt(14)
  v_dot2_f32_bf16 v69, v168, v20, 0
  v_dot2_f32_bf16 v69, v169, v21, v69
  v_dot2_f32_bf16 v69, v170, v22, v69
  v_dot2_f32_bf16 v69, v171, v23, v69
  buffer_load_dwordx4 v[216:219], v9, s[48:51], s94 offen offset:1024 nt
  s_waitcnt vmcnt(14)
  v_dot2_f32_bf16 v70, v172, v20, 0
  v_dot2_f32_bf16 v70, v173, v21, v70
  v_dot2_f32_bf16 v70, v174, v22, v70
  v_dot2_f32_bf16 v70, v175, v23, v70
  buffer_load_dwordx4 v[220:223], v9, s[48:51], s94 offen offset:2048 nt
  buffer_load_dwordx4 a[72:75], v10, s[56:59], s95 offen offset:768
  s_waitcnt vmcnt(14)
  v_dot2_f32_bf16 v71, v176, v20, 0
  v_dot2_f32_bf16 v71, v177, v21, v71
  v_dot2_f32_bf16 v71, v178, v22, v71
  v_dot2_f32_bf16 v71, v179, v23, v71
  buffer_load_dwordx4 v[224:227], v9, s[48:51], s94 offen offset:3072 nt
  s_waitcnt vmcnt(14)
  v_dot2_f32_bf16 v72, v180, v20, 0
  v_dot2_f32_bf16 v72, v181, v21, v72
  v_dot2_f32_bf16 v72, v182, v22, v72
  v_dot2_f32_bf16 v72, v183, v23, v72
  s_xor_b32 s94, s23, 16384
  buffer_load_dwordx4 v[228:231], v9, s[48:51], s94 offen offset:0 nt
  s_waitcnt vmcnt(14)
  v_dot2_f32_bf16 v73, v184, v20, 0
  v_dot2_f32_bf16 v73, v185, v21, v73
  v_dot2_f32_bf16 v73, v186, v22, v73
  v_dot2_f32_bf16 v73, v187, v23, v73
  buffer_load_dwordx4 v[232:235], v9, s[48:51], s94 offen offset:1024 nt
  s_waitcnt vmcnt(14)
  v_dot2_f32_bf16 v74, v188, v20, 0
  v_dot2_f32_bf16 v74, v189, v21, v74
  v_dot2_f32_bf16 v74, v190, v22, v74
  v_dot2_f32_bf16 v74, v191, v23, v74
  buffer_load_dwordx4 v[236:239], v9, s[48:51], s94 offen offset:2048 nt
  buffer_load_dwordx4 a[76:79], v10, s[56:59], s95 offen offset:1024
  s_waitcnt vmcnt(14)
  v_dot2_f32_bf16 v75, v192, v20, 0
  v_dot2_f32_bf16 v75, v193, v21, v75
  v_dot2_f32_bf16 v75, v194, v22, v75
  v_dot2_f32_bf16 v75, v195, v23, v75
  buffer_load_dwordx4 v[240:243], v9, s[48:51], s94 offen offset:3072 nt
  s_waitcnt vmcnt(14)
  v_dot2_f32_bf16 v76, v196, v20, 0
  v_dot2_f32_bf16 v76, v197, v21, v76
  v_dot2_f32_bf16 v76, v198, v22, v76
  v_dot2_f32_bf16 v76, v199, v23, v76
  s_xor_b32 s94, s23, 32768
  buffer_load_dwordx4 v[244:247], v9, s[48:51], s94 offen offset:0 nt
  s_waitcnt vmcnt(14)
  v_dot2_f32_bf16 v77, v200, v20, 0
  v_dot2_f32_bf16 v77, v201, v21, v77
  v_dot2_f32_bf16 v77, v202, v22, v77
  v_dot2_f32_bf16 v77, v203, v23, v77
  buffer_load_dwordx4 v[248:251], v9, s[48:51], s94 offen offset:1024 nt
  s_waitcnt vmcnt(14)
  v_dot2_f32_bf16 v78, v204, v20, 0
  v_dot2_f32_bf16 v78, v205, v21, v78
  v_dot2_f32_bf16 v78, v206, v22, v78
  v_dot2_f32_bf16 v78, v207, v23, v78
  buffer_load_dwordx4 v[252:255], v9, s[48:51], s94 offen offset:2048 nt
  buffer_load_dwordx4 a[80:83], v10, s[56:59], s95 offen offset:1280
  s_waitcnt vmcnt(14)
  v_dot2_f32_bf16 v79, v208, v20, 0
  v_dot2_f32_bf16 v79, v209, v21, v79
  v_dot2_f32_bf16 v79, v210, v22, v79
  v_dot2_f32_bf16 v79, v211, v23, v79
  buffer_load_dwordx4 v[132:135], v9, s[48:51], s94 offen offset:3072 nt
  v_add_f32_dpp v64, v64, v64 row_ror:8 row_mask:0xf bank_mask:0x3
  v_add_f32_dpp v65, v65, v65 row_ror:8 row_mask:0xf bank_mask:0x3
  v_add_f32_dpp v66, v66, v66 row_ror:8 row_mask:0xf bank_mask:0x3
  v_add_f32_dpp v67, v67, v67 row_ror:8 row_mask:0xf bank_mask:0x3
  v_add_f32_dpp v68, v68, v68 row_ror:8 row_mask:0xf bank_mask:0x3
  v_add_f32_dpp v69, v69, v69 row_ror:8 row_mask:0xf bank_mask:0x3
  v_add_f32_dpp v70, v70, v70 row_ror:8 row_mask:0xf bank_mask:0x3
  v_add_f32_dpp v71, v71, v71 row_ror:8 row_mask:0xf bank_mask:0x3
  v_add_f32_dpp v64, v72, v72 row_ror:8 row_mask:0xf bank_mask:0xc
  v_add_f32_dpp v65, v73, v73 row_ror:8 row_mask:0xf bank_mask:0xc
  v_add_f32_dpp v66, v74, v74 row_ror:8 row_mask:0xf bank_mask:0xc
  v_add_f32_dpp v67, v75, v75 row_ror:8 row_mask:0xf bank_mask:0xc
  v_add_f32_dpp v68, v76, v76 row_ror:8 row_mask:0xf bank_mask:0xc
  v_add_f32_dpp v69, v77, v77 row_ror:8 row_mask:0xf bank_mask:0xc
  v_add_f32_dpp v70, v78, v78 row_ror:8 row_mask:0xf bank_mask:0xc
  v_add_f32_dpp v71, v79, v79 row_ror:8 row_mask:0xf bank_mask:0xc
  v_add_f32_dpp v64, v64, v64 row_half_mirror row_mask:0xf bank_mask:0x5
  v_add_f32_dpp v65, v65, v65 row_half_mirror row_mask:0xf bank_mask:0x5
  v_add_f32_dpp v66, v66, v66 row_half_mirror row_mask:0xf bank_mask:0x5
  v_add_f32_dpp v67, v67, v67 row_half_mirror row_mask:0xf bank_mask:0x5
  v_add_f32_dpp v64, v68, v68 row_half_mirror row_mask:0xf bank_mask:0xa
  v_add_f32_dpp v65, v69, v69 row_half_mirror row_mask:0xf bank_mask:0xa
  v_add_f32_dpp v66, v70, v70 row_half_mirror row_mask:0xf bank_mask:0xa
  v_add_f32_dpp v67, v71, v71 row_half_mirror row_mask:0xf bank_mask:0xa
  v_cndmask_b32 v68, v66, v64, s[88:89]
  v_cndmask_b32 v69, v67, v65, s[88:89]
  v_cndmask_b32 v70, v64, v66, s[88:89]
  v_cndmask_b32 v71, v65, v67, s[88:89]
  v_add_f32_dpp v64, v68, v70 quad_perm:[2,3,0,1] row_mask:0xf bank_mask:0xf
  v_add_f32_dpp v65, v69, v71 quad_perm:[2,3,0,1] row_mask:0xf bank_mask:0xf
  v_cndmask_b32 v66, v65, v64, s[90:91]
  v_cndmask_b32 v67, v64, v65, s[90:91]
  s_nop 0
  v_add_f32_dpp v31, v66, v67 quad_perm:[1,0,3,2] row_mask:0xf bank_mask:0xf
  v_cvt_pk_bf16_f32 v64, v30, v31
  v_lshlrev_b32 v30, 16, v64
  v_and_b32 v31, 0xffff0000, v64
  v_mul_f32 v30, 0x3db504f3, v30
  v_mul_f32 v31, 0x3db504f3, v31
  v_cvt_pk_bf16_f32 v64, v30, v31
  v_lshlrev_b32 v30, 16, v64
  v_and_b32 v31, 0xffff0000, v64
  v_max3_f32 v81, v24, v25, v26
  v_max3_f32 v4, v27, v28, v29
  v_max3_f32 v81, v81, v30, v31
  v_max_f32 v81, v81, v4
  s_nop 1
  v_max_f32_dpp v81, v81, v81 quad_perm:[1,0,3,2] row_mask:0xf bank_mask:0xf
  s_nop 1
  v_max_f32_dpp v81, v81, v81 quad_perm:[2,3,0,1] row_mask:0xf bank_mask:0xf
  s_nop 1
  v_max_f32_dpp v81, v81, v81 row_half_mirror row_mask:0xf bank_mask:0xf
  s_nop 1
  v_max_f32_dpp v81, v81, v81 row_ror:8 row_mask:0xf bank_mask:0xf
  v_mov_b32 v4, v81
  s_nop 1
  v_permlane16_swap_b32 v4, v81
  v_max_f32 v81, v81, v4
  v_mov_b32 v4, v81
  s_nop 1
  v_permlane32_swap_b32 v4, v81
  v_max_f32 v81, v81, v4
  v_sub_f32 v24, v24, v81
  v_sub_f32 v25, v25, v81
  v_sub_f32 v26, v26, v81
  v_sub_f32 v27, v27, v81
  v_sub_f32 v28, v28, v81
  v_sub_f32 v29, v29, v81
  v_sub_f32 v30, v30, v81
  v_sub_f32 v31, v31, v81
  v_mul_f32 v24, 0x3fb8aa3b, v24
  v_mul_f32 v25, 0x3fb8aa3b, v25
  v_mul_f32 v26, 0x3fb8aa3b, v26
  v_mul_f32 v27, 0x3fb8aa3b, v27
  v_mul_f32 v28, 0x3fb8aa3b, v28
  v_mul_f32 v29, 0x3fb8aa3b, v29
  v_mul_f32 v30, 0x3fb8aa3b, v30
  v_mul_f32 v31, 0x3fb8aa3b, v31
  v_exp_f32 v24, v24
  v_exp_f32 v25, v25
  v_exp_f32 v26, v26
  v_exp_f32 v27, v27
  v_exp_f32 v28, v28
  v_exp_f32 v29, v29
  v_exp_f32 v30, v30
  v_exp_f32 v31, v31
  v_add_f32 v4, v24, v25
  v_add_f32 v5, v26, v27
  v_add_f32 v6, v28, v29
  v_add_f32 v7, v30, v31
  v_add_f32 v4, v4, v5
  v_add_f32 v6, v6, v7
  v_add_f32 v82, v4, v6
  v_cvt_pk_bf16_f32 v64, v24, v24
  v_cvt_pk_bf16_f32 v65, v25, v25
  v_cvt_pk_bf16_f32 v66, v26, v26
  v_cvt_pk_bf16_f32 v67, v27, v27
  v_cvt_pk_bf16_f32 v68, v28, v28
  v_cvt_pk_bf16_f32 v69, v29, v29
  v_cvt_pk_bf16_f32 v70, v30, v30
  v_cvt_pk_bf16_f32 v71, v31, v31
  v_lshlrev_b32 v64, 16, v64
  v_lshlrev_b32 v65, 16, v65
  v_lshlrev_b32 v66, 16, v66
  v_lshlrev_b32 v67, 16, v67
  v_lshlrev_b32 v68, 16, v68
  v_lshlrev_b32 v69, 16, v69
  v_lshlrev_b32 v70, 16, v70
  v_lshlrev_b32 v71, 16, v71
  v_sub_f32 v64, v24, v64
  v_sub_f32 v65, v25, v65
  v_sub_f32 v66, v26, v66
  v_sub_f32 v67, v27, v67
  v_sub_f32 v68, v28, v68
  v_sub_f32 v69, v29, v69
  v_sub_f32 v70, v30, v70
  v_sub_f32 v71, v31, v71
  v_cvt_pk_bf16_f32 v24, v24, v64
  v_cvt_pk_bf16_f32 v25, v25, v65
  v_cvt_pk_bf16_f32 v26, v26, v66
  v_cvt_pk_bf16_f32 v27, v27, v67
  v_cvt_pk_bf16_f32 v28, v28, v68
  v_cvt_pk_bf16_f32 v29, v29, v69
  v_cvt_pk_bf16_f32 v30, v30, v70
  v_cvt_pk_bf16_f32 v31, v31, v71
  v_add_f32_dpp v82, v82, v82 quad_perm:[1,0,3,2] row_mask:0xf bank_mask:0xf
  s_nop 1
  v_add_f32_dpp v82, v82, v82 quad_perm:[2,3,0,1] row_mask:0xf bank_mask:0xf
  s_nop 1
  v_add_f32_dpp v82, v82, v82 row_half_mirror row_mask:0xf bank_mask:0xf
  s_nop 1
  v_add_f32_dpp v82, v82, v82 row_ror:8 row_mask:0xf bank_mask:0xf
  v_mov_b32 v4, v82
  s_nop 1
  v_permlane16_swap_b32 v4, v82
  v_add_f32 v82, v82, v4
  v_mov_b32 v4, v82
  s_nop 1
  v_permlane32_swap_b32 v4, v82
  v_add_f32 v82, v82, v4
  v_min_u32 v88, -2, v81
  v_min_u32 v89, -2, v82
  s_mov_b64 exec, 1
  buffer_store_dwordx2 v[88:89], v84, s[76:79], 0 offen sc1
  s_mov_b64 exec, -1
  v_mov_b32_dpp v4, v24 row_newbcast:0 row_mask:0xf bank_mask:0xf
  v_perm_b32 v56, v4, v4, v16
  v_perm_b32 v57, v4, v4, v17
  v_perm_b32 v58, v4, v4, v18
  v_perm_b32 v59, v4, v4, v19
  v_mov_b32_dpp v5, v24 row_newbcast:1 row_mask:0xf bank_mask:0xf
  v_perm_b32 v60, v5, v5, v16
  v_perm_b32 v61, v5, v5, v17
  v_perm_b32 v62, v5, v5, v18
  v_perm_b32 v63, v5, v5, v19
  s_waitcnt vmcnt(15)
  v_mfma_f32_16x16x32_bf16 v[52:55], v[56:59], v[212:215], 0
  s_xor_b32 s94, s23, 49152
  buffer_load_dwordx4 v[136:139], v9, s[48:51], s94 offen offset:0 nt
  v_mov_b32_dpp v4, v24 row_newbcast:2 row_mask:0xf bank_mask:0xf
  v_perm_b32 v56, v4, v4, v16
  v_perm_b32 v57, v4, v4, v17
  v_perm_b32 v58, v4, v4, v18
  v_perm_b32 v59, v4, v4, v19
  s_waitcnt vmcnt(15)
  v_mfma_f32_16x16x32_bf16 v[52:55], v[60:63], v[216:219], v[52:55]
  buffer_load_dwordx4 v[140:143], v9, s[48:51], s94 offen offset:1024 nt
  v_mov_b32_dpp v5, v24 row_newbcast:3 row_mask:0xf bank_mask:0xf
  v_perm_b32 v60, v5, v5, v16
  v_perm_b32 v61, v5, v5, v17
  v_perm_b32 v62, v5, v5, v18
  v_perm_b32 v63, v5, v5, v19
  s_waitcnt vmcnt(15)
  v_mfma_f32_16x16x32_bf16 v[52:55], v[56:59], v[220:223], v[52:55]
  buffer_load_dwordx4 v[144:147], v9, s[48:51], s94 offen offset:2048 nt
  buffer_load_dwordx4 a[84:87], v10, s[56:59], s95 offen offset:1536
  v_mov_b32_dpp v4, v24 row_newbcast:4 row_mask:0xf bank_mask:0xf
  v_perm_b32 v56, v4, v4, v16
  v_perm_b32 v57, v4, v4, v17
  v_perm_b32 v58, v4, v4, v18
  v_perm_b32 v59, v4, v4, v19
  s_waitcnt vmcnt(15)
  v_mfma_f32_16x16x32_bf16 v[52:55], v[60:63], v[224:227], v[52:55]
  buffer_load_dwordx4 v[148:151], v9, s[48:51], s94 offen offset:3072 nt
  v_mov_b32_dpp v5, v24 row_newbcast:5 row_mask:0xf bank_mask:0xf
  v_perm_b32 v60, v5, v5, v16
  v_perm_b32 v61, v5, v5, v17
  v_perm_b32 v62, v5, v5, v18
  v_perm_b32 v63, v5, v5, v19
  s_waitcnt vmcnt(15)
  v_mfma_f32_16x16x32_bf16 v[52:55], v[56:59], v[228:231], v[52:55]
  s_xor_b32 s94, s23, 65536
  buffer_load_dwordx4 v[152:155], v9, s[48:51], s94 offen offset:0 nt
  v_mov_b32_dpp v4, v24 row_newbcast:6 row_mask:0xf bank_mask:0xf
  v_perm_b32 v56, v4, v4, v16
  v_perm_b32 v57, v4, v4, v17
  v_perm_b32 v58, v4, v4, v18
  v_perm_b32 v59, v4, v4, v19
  s_waitcnt vmcnt(15)
  v_mfma_f32_16x16x32_bf16 v[52:55], v[60:63], v[232:235], v[52:55]
  buffer_load_dwordx4 v[156:159], v9, s[48:51], s94 offen offset:1024 nt
  v_mov_b32_dpp v5, v24 row_newbcast:7 row_mask:0xf bank_mask:0xf
  v_perm_b32 v60, v5, v5, v16
  v_perm_b32 v61, v5, v5, v17
  v_perm_b32 v62, v5, v5, v18
  v_perm_b32 v63, v5, v5, v19
  s_waitcnt vmcnt(15)
  v_mfma_f32_16x16x32_bf16 v[52:55], v[56:59], v[236:239], v[52:55]
  buffer_load_dwordx4 v[160:163], v9, s[48:51], s94 offen offset:2048 nt
  buffer_load_dwordx4 a[88:91], v10, s[56:59], s95 offen offset:1792
  v_mov_b32_dpp v4, v24 row_newbcast:8 row_mask:0xf bank_mask:0xf
  v_perm_b32 v56, v4, v4, v16
  v_perm_b32 v57, v4, v4, v17
  v_perm_b32 v58, v4, v4, v18
  v_perm_b32 v59, v4, v4, v19
  s_waitcnt vmcnt(15)
  v_mfma_f32_16x16x32_bf16 v[52:55], v[60:63], v[240:243], v[52:55]
  buffer_load_dwordx4 v[164:167], v9, s[48:51], s94 offen offset:3072 nt
  v_mov_b32_dpp v5, v24 row_newbcast:9 row_mask:0xf bank_mask:0xf
  v_perm_b32 v60, v5, v5, v16
  v_perm_b32 v61, v5, v5, v17
  v_perm_b32 v62, v5, v5, v18
  v_perm_b32 v63, v5, v5, v19
  s_waitcnt vmcnt(15)
  v_mfma_f32_16x16x32_bf16 v[52:55], v[56:59], v[244:247], v[52:55]
  s_xor_b32 s94, s23, 81920
  buffer_load_dwordx4 v[112:115], v9, s[48:51], s94 offen offset:0 nt
  v_mov_b32_dpp v4, v24 row_newbcast:10 row_mask:0xf bank_mask:0xf
  v_perm_b32 v56, v4, v4, v16
  v_perm_b32 v57, v4, v4, v17
  v_perm_b32 v58, v4, v4, v18
  v_perm_b32 v59, v4, v4, v19
  s_waitcnt vmcnt(15)
  v_mfma_f32_16x16x32_bf16 v[52:55], v[60:63], v[248:251], v[52:55]
  buffer_load_dwordx4 v[116:119], v9, s[48:51], s94 offen offset:1024 nt
  v_mov_b32_dpp v5, v24 row_newbcast:11 row_mask:0xf bank_mask:0xf
  v_perm_b32 v60, v5, v5, v16
  v_perm_b32 v61, v5, v5, v17
  v_perm_b32 v62, v5, v5, v18
  v_perm_b32 v63, v5, v5, v19
  s_waitcnt vmcnt(15)
  v_mfma_f32_16x16x32_bf16 v[52:55], v[56:59], v[252:255], v[52:55]
  buffer_load_dwordx4 v[120:123], v9, s[48:51], s94 offen offset:2048 nt
  buffer_load_dwordx4 a[92:95], v10, s[56:59], s95 offen offset:2048
  v_mov_b32_dpp v4, v24 row_newbcast:12 row_mask:0xf bank_mask:0xf
  v_perm_b32 v56, v4, v4, v16
  v_perm_b32 v57, v4, v4, v17
  v_perm_b32 v58, v4, v4, v18
  v_perm_b32 v59, v4, v4, v19
  s_waitcnt vmcnt(15)
  v_mfma_f32_16x16x32_bf16 v[52:55], v[60:63], v[132:135], v[52:55]
  buffer_load_dwordx4 v[124:127], v9, s[48:51], s94 offen offset:3072 nt
  v_mov_b32_dpp v5, v24 row_newbcast:13 row_mask:0xf bank_mask:0xf
  v_perm_b32 v60, v5, v5, v16
  v_perm_b32 v61, v5, v5, v17
  v_perm_b32 v62, v5, v5, v18
  v_perm_b32 v63, v5, v5, v19
  s_waitcnt vmcnt(14)
  v_mfma_f32_16x16x32_bf16 v[52:55], v[56:59], v[136:139], v[52:55]
  s_xor_b32 s94, s23, 98304
  buffer_load_dwordx4 v[128:131], v9, s[48:51], s94 offen offset:0 nt
  v_mov_b32_dpp v4, v24 row_newbcast:14 row_mask:0xf bank_mask:0xf
  v_perm_b32 v56, v4, v4, v16
  v_perm_b32 v57, v4, v4, v17
  v_perm_b32 v58, v4, v4, v18
  v_perm_b32 v59, v4, v4, v19
  s_waitcnt vmcnt(14)
  v_mfma_f32_16x16x32_bf16 v[52:55], v[60:63], v[140:143], v[52:55]
  buffer_load_dwordx4 v[168:171], v9, s[48:51], s94 offen offset:1024 nt
  v_mov_b32_dpp v5, v24 row_newbcast:15 row_mask:0xf bank_mask:0xf
  v_perm_b32 v60, v5, v5, v16
  v_perm_b32 v61, v5, v5, v17
  v_perm_b32 v62, v5, v5, v18
  v_perm_b32 v63, v5, v5, v19
  s_waitcnt vmcnt(14)
  v_mfma_f32_16x16x32_bf16 v[52:55], v[56:59], v[144:147], v[52:55]
  buffer_load_dwordx4 v[172:175], v9, s[48:51], s94 offen offset:2048 nt
  buffer_load_dwordx4 a[96:99], v10, s[56:59], s95 offen offset:2304
  v_mov_b32_dpp v4, v25 row_newbcast:0 row_mask:0xf bank_mask:0xf
  v_perm_b32 v56, v4, v4, v16
  v_perm_b32 v57, v4, v4, v17
  v_perm_b32 v58, v4, v4, v18
  v_perm_b32 v59, v4, v4, v19
  s_waitcnt vmcnt(14)
  v_mfma_f32_16x16x32_bf16 v[52:55], v[60:63], v[148:151], v[52:55]
  buffer_load_dwordx4 v[176:179], v9, s[48:51], s94 offen offset:3072 nt
  v_mov_b32_dpp v5, v25 row_newbcast:1 row_mask:0xf bank_mask:0xf
  v_perm_b32 v60, v5, v5, v16
  v_perm_b32 v61, v5, v5, v17
  v_perm_b32 v62, v5, v5, v18
  v_perm_b32 v63, v5, v5, v19
  s_waitcnt vmcnt(14)
  v_mfma_f32_16x16x32_bf16 v[52:55], v[56:59], v[152:155], v[52:55]
  s_xor_b32 s94, s23, 114688
  buffer_load_dwordx4 v[180:183], v9, s[48:51], s94 offen offset:0 nt
  v_mov_b32_dpp v4, v25 row_newbcast:2 row_mask:0xf bank_mask:0xf
  v_perm_b32 v56, v4, v4, v16
  v_perm_b32 v57, v4, v4, v17
  v_perm_b32 v58, v4, v4, v18
  v_perm_b32 v59, v4, v4, v19
  s_waitcnt vmcnt(14)
  v_mfma_f32_16x16x32_bf16 v[52:55], v[60:63], v[156:159], v[52:55]
  buffer_load_dwordx4 v[184:187], v9, s[48:51], s94 offen offset:1024 nt
  v_mov_b32_dpp v5, v25 row_newbcast:3 row_mask:0xf bank_mask:0xf
  v_perm_b32 v60, v5, v5, v16
  v_perm_b32 v61, v5, v5, v17
  v_perm_b32 v62, v5, v5, v18
  v_perm_b32 v63, v5, v5, v19
  s_waitcnt vmcnt(14)
  v_mfma_f32_16x16x32_bf16 v[52:55], v[56:59], v[160:163], v[52:55]
  buffer_load_dwordx4 v[188:191], v9, s[48:51], s94 offen offset:2048 nt
  buffer_load_dwordx4 a[100:103], v10, s[56:59], s95 offen offset:2560
  v_mov_b32_dpp v4, v25 row_newbcast:4 row_mask:0xf bank_mask:0xf
  v_perm_b32 v56, v4, v4, v16
  v_perm_b32 v57, v4, v4, v17
  v_perm_b32 v58, v4, v4, v18
  v_perm_b32 v59, v4, v4, v19
  s_waitcnt vmcnt(14)
  v_mfma_f32_16x16x32_bf16 v[52:55], v[60:63], v[164:167], v[52:55]
  buffer_load_dwordx4 v[192:195], v9, s[48:51], s94 offen offset:3072 nt
  v_mov_b32_dpp v5, v25 row_newbcast:5 row_mask:0xf bank_mask:0xf
  v_perm_b32 v60, v5, v5, v16
  v_perm_b32 v61, v5, v5, v17
  v_perm_b32 v62, v5, v5, v18
  v_perm_b32 v63, v5, v5, v19
  s_waitcnt vmcnt(14)
  v_mfma_f32_16x16x32_bf16 v[52:55], v[56:59], v[112:115], v[52:55]
  s_xor_b32 s94, s23, 131072
  buffer_load_dwordx4 v[196:199], v9, s[48:51], s94 offen offset:0 nt
  v_mov_b32_dpp v4, v25 row_newbcast:6 row_mask:0xf bank_mask:0xf
  v_perm_b32 v56, v4, v4, v16
  v_perm_b32 v57, v4, v4, v17
  v_perm_b32 v58, v4, v4, v18
  v_perm_b32 v59, v4, v4, v19
  s_waitcnt vmcnt(14)
  v_mfma_f32_16x16x32_bf16 v[52:55], v[60:63], v[116:119], v[52:55]
  buffer_load_dwordx4 v[200:203], v9, s[48:51], s94 offen offset:1024 nt
  v_mov_b32_dpp v5, v25 row_newbcast:7 row_mask:0xf bank_mask:0xf
  v_perm_b32 v60, v5, v5, v16
  v_perm_b32 v61, v5, v5, v17
  v_perm_b32 v62, v5, v5, v18
  v_perm_b32 v63, v5, v5, v19
  s_waitcnt vmcnt(14)
  v_mfma_f32_16x16x32_bf16 v[52:55], v[56:59], v[120:123], v[52:55]
  buffer_load_dwordx4 v[204:207], v9, s[48:51], s94 offen offset:2048 nt
  buffer_load_dwordx4 a[104:107], v10, s[56:59], s95 offen offset:2816
  v_mov_b32_dpp v4, v25 row_newbcast:8 row_mask:0xf bank_mask:0xf
  v_perm_b32 v56, v4, v4, v16
  v_perm_b32 v57, v4, v4, v17
  v_perm_b32 v58, v4, v4, v18
  v_perm_b32 v59, v4, v4, v19
  s_waitcnt vmcnt(14)
  v_mfma_f32_16x16x32_bf16 v[52:55], v[60:63], v[124:127], v[52:55]
  buffer_load_dwordx4 v[208:211], v9, s[48:51], s94 offen offset:3072 nt
  v_mov_b32_dpp v5, v25 row_newbcast:9 row_mask:0xf bank_mask:0xf
  v_perm_b32 v60, v5, v5, v16
  v_perm_b32 v61, v5, v5, v17
  v_perm_b32 v62, v5, v5, v18
  v_perm_b32 v63, v5, v5, v19
  s_waitcnt vmcnt(14)
  v_mfma_f32_16x16x32_bf16 v[52:55], v[56:59], v[128:131], v[52:55]
  s_xor_b32 s94, s23, 147456
  buffer_load_dwordx4 v[212:215], v9, s[48:51], s94 offen offset:0 nt
  v_mov_b32_dpp v4, v25 row_newbcast:10 row_mask:0xf bank_mask:0xf
  v_perm_b32 v56, v4, v4, v16
  v_perm_b32 v57, v4, v4, v17
  v_perm_b32 v58, v4, v4, v18
  v_perm_b32 v59, v4, v4, v19
  s_waitcnt vmcnt(14)
  v_mfma_f32_16x16x32_bf16 v[52:55], v[60:63], v[168:171], v[52:55]
  buffer_load_dwordx4 v[216:219], v9, s[48:51], s94 offen offset:1024 nt
  v_mov_b32_dpp v5, v25 row_newbcast:11 row_mask:0xf bank_mask:0xf
  v_perm_b32 v60, v5, v5, v16
  v_perm_b32 v61, v5, v5, v17
  v_perm_b32 v62, v5, v5, v18
  v_perm_b32 v63, v5, v5, v19
  s_waitcnt vmcnt(14)
  v_mfma_f32_16x16x32_bf16 v[52:55], v[56:59], v[172:175], v[52:55]
  buffer_load_dwordx4 v[220:223], v9, s[48:51], s94 offen offset:2048 nt
  buffer_load_dwordx4 a[108:111], v10, s[56:59], s95 offen offset:3072
  v_mov_b32_dpp v4, v25 row_newbcast:12 row_mask:0xf bank_mask:0xf
  v_perm_b32 v56, v4, v4, v16
  v_perm_b32 v57, v4, v4, v17
  v_perm_b32 v58, v4, v4, v18
  v_perm_b32 v59, v4, v4, v19
  s_waitcnt vmcnt(14)
  v_mfma_f32_16x16x32_bf16 v[52:55], v[60:63], v[176:179], v[52:55]
  buffer_load_dwordx4 v[224:227], v9, s[48:51], s94 offen offset:3072 nt
  v_mov_b32_dpp v5, v25 row_newbcast:13 row_mask:0xf bank_mask:0xf
  v_perm_b32 v60, v5, v5, v16
  v_perm_b32 v61, v5, v5, v17
  v_perm_b32 v62, v5, v5, v18
  v_perm_b32 v63, v5, v5, v19
  s_waitcnt vmcnt(14)
  v_mfma_f32_16x16x32_bf16 v[52:55], v[56:59], v[180:183], v[52:55]
  s_xor_b32 s94, s23, 163840
  buffer_load_dwordx4 v[228:231], v9, s[48:51], s94 offen offset:0 nt
  v_mov_b32_dpp v4, v25 row_newbcast:14 row_mask:0xf bank_mask:0xf
  v_perm_b32 v56, v4, v4, v16
  v_perm_b32 v57, v4, v4, v17
  v_perm_b32 v58, v4, v4, v18
  v_perm_b32 v59, v4, v4, v19
  s_waitcnt vmcnt(14)
  v_mfma_f32_16x16x32_bf16 v[52:55], v[60:63], v[184:187], v[52:55]
  buffer_load_dwordx4 v[232:235], v9, s[48:51], s94 offen offset:1024 nt
  v_mov_b32_dpp v5, v25 row_newbcast:15 row_mask:0xf bank_mask:0xf
  v_perm_b32 v60, v5, v5, v16
  v_perm_b32 v61, v5, v5, v17
  v_perm_b32 v62, v5, v5, v18
  v_perm_b32 v63, v5, v5, v19
  s_waitcnt vmcnt(14)
  v_mfma_f32_16x16x32_bf16 v[52:55], v[56:59], v[188:191], v[52:55]
  buffer_load_dwordx4 v[236:239], v9, s[48:51], s94 offen offset:2048 nt
  buffer_load_dwordx4 a[112:115], v10, s[56:59], s95 offen offset:3328
  v_mov_b32_dpp v4, v26 row_newbcast:0 row_mask:0xf bank_mask:0xf
  v_perm_b32 v56, v4, v4, v16
  v_perm_b32 v57, v4, v4, v17
  v_perm_b32 v58, v4, v4, v18
  v_perm_b32 v59, v4, v4, v19
  s_waitcnt vmcnt(14)
  v_mfma_f32_16x16x32_bf16 v[52:55], v[60:63], v[192:195], v[52:55]
  buffer_load_dwordx4 v[240:243], v9, s[48:51], s94 offen offset:3072 nt
  v_mov_b32_dpp v5, v26 row_newbcast:1 row_mask:0xf bank_mask:0xf
  v_perm_b32 v60, v5, v5, v16
  v_perm_b32 v61, v5, v5, v17
  v_perm_b32 v62, v5, v5, v18
  v_perm_b32 v63, v5, v5, v19
  s_waitcnt vmcnt(14)
  v_mfma_f32_16x16x32_bf16 v[52:55], v[56:59], v[196:199], v[52:55]
  s_xor_b32 s94, s23, 180224
  buffer_load_dwordx4 v[244:247], v9, s[48:51], s94 offen offset:0 nt
  v_mov_b32_dpp v4, v26 row_newbcast:2 row_mask:0xf bank_mask:0xf
  v_perm_b32 v56, v4, v4, v16
  v_perm_b32 v57, v4, v4, v17
  v_perm_b32 v58, v4, v4, v18
  v_perm_b32 v59, v4, v4, v19
  s_waitcnt vmcnt(14)
  v_mfma_f32_16x16x32_bf16 v[52:55], v[60:63], v[200:203], v[52:55]
  buffer_load_dwordx4 v[248:251], v9, s[48:51], s94 offen offset:1024 nt
  v_mov_b32_dpp v5, v26 row_newbcast:3 row_mask:0xf bank_mask:0xf
  v_perm_b32 v60, v5, v5, v16
  v_perm_b32 v61, v5, v5, v17
  v_perm_b32 v62, v5, v5, v18
  v_perm_b32 v63, v5, v5, v19
  s_waitcnt vmcnt(14)
  v_mfma_f32_16x16x32_bf16 v[52:55], v[56:59], v[204:207], v[52:55]
  buffer_load_dwordx4 v[252:255], v9, s[48:51], s94 offen offset:2048 nt
  buffer_load_dwordx4 a[116:119], v10, s[56:59], s95 offen offset:3584
  v_mov_b32_dpp v4, v26 row_newbcast:4 row_mask:0xf bank_mask:0xf
  v_perm_b32 v56, v4, v4, v16
  v_perm_b32 v57, v4, v4, v17
  v_perm_b32 v58, v4, v4, v18
  v_perm_b32 v59, v4, v4, v19
  s_waitcnt vmcnt(14)
  v_mfma_f32_16x16x32_bf16 v[52:55], v[60:63], v[208:211], v[52:55]
  buffer_load_dwordx4 v[132:135], v9, s[48:51], s94 offen offset:3072 nt
  v_mov_b32_dpp v5, v26 row_newbcast:5 row_mask:0xf bank_mask:0xf
  v_perm_b32 v60, v5, v5, v16
  v_perm_b32 v61, v5, v5, v17
  v_perm_b32 v62, v5, v5, v18
  v_perm_b32 v63, v5, v5, v19
  s_waitcnt vmcnt(14)
  v_mfma_f32_16x16x32_bf16 v[52:55], v[56:59], v[212:215], v[52:55]
  s_xor_b32 s94, s23, 196608
  buffer_load_dwordx4 v[136:139], v9, s[48:51], s94 offen offset:0 nt
  v_mov_b32_dpp v4, v26 row_newbcast:6 row_mask:0xf bank_mask:0xf
  v_perm_b32 v56, v4, v4, v16
  v_perm_b32 v57, v4, v4, v17
  v_perm_b32 v58, v4, v4, v18
  v_perm_b32 v59, v4, v4, v19
  s_waitcnt vmcnt(14)
  v_mfma_f32_16x16x32_bf16 v[52:55], v[60:63], v[216:219], v[52:55]
  buffer_load_dwordx4 v[140:143], v9, s[48:51], s94 offen offset:1024 nt
  v_mov_b32_dpp v5, v26 row_newbcast:7 row_mask:0xf bank_mask:0xf
  v_perm_b32 v60, v5, v5, v16
  v_perm_b32 v61, v5, v5, v17
  v_perm_b32 v62, v5, v5, v18
  v_perm_b32 v63, v5, v5, v19
  s_waitcnt vmcnt(14)
  v_mfma_f32_16x16x32_bf16 v[52:55], v[56:59], v[220:223], v[52:55]
  buffer_load_dwordx4 v[144:147], v9, s[48:51], s94 offen offset:2048 nt
  s_mov_b32 s95, 7680
  buffer_load_dwordx4 a[120:123], v10, s[56:59], s95 offen offset:0
  v_mov_b32_dpp v4, v26 row_newbcast:8 row_mask:0xf bank_mask:0xf
  v_perm_b32 v56, v4, v4, v16
  v_perm_b32 v57, v4, v4, v17
  v_perm_b32 v58, v4, v4, v18
  v_perm_b32 v59, v4, v4, v19
  s_waitcnt vmcnt(14)
  v_mfma_f32_16x16x32_bf16 v[52:55], v[60:63], v[224:227], v[52:55]
  buffer_load_dwordx4 v[148:151], v9, s[48:51], s94 offen offset:3072 nt
  v_mov_b32_dpp v5, v26 row_newbcast:9 row_mask:0xf bank_mask:0xf
  v_perm_b32 v60, v5, v5, v16
  v_perm_b32 v61, v5, v5, v17
  v_perm_b32 v62, v5, v5, v18
  v_perm_b32 v63, v5, v5, v19
  s_waitcnt vmcnt(14)
  v_mfma_f32_16x16x32_bf16 v[52:55], v[56:59], v[228:231], v[52:55]
  s_xor_b32 s94, s23, 212992
  buffer_load_dwordx4 v[152:155], v9, s[48:51], s94 offen offset:0 nt
  v_mov_b32_dpp v4, v26 row_newbcast:10 row_mask:0xf bank_mask:0xf
  v_perm_b32 v56, v4, v4, v16
  v_perm_b32 v57, v4, v4, v17
  v_perm_b32 v58, v4, v4, v18
  v_perm_b32 v59, v4, v4, v19
  s_waitcnt vmcnt(14)
  v_mfma_f32_16x16x32_bf16 v[52:55], v[60:63], v[232:235], v[52:55]
  buffer_load_dwordx4 v[156:159], v9, s[48:51], s94 offen offset:1024 nt
  v_mov_b32_dpp v5, v26 row_newbcast:11 row_mask:0xf bank_mask:0xf
  v_perm_b32 v60, v5, v5, v16
  v_perm_b32 v61, v5, v5, v17
  v_perm_b32 v62, v5, v5, v18
  v_perm_b32 v63, v5, v5, v19
  s_waitcnt vmcnt(14)
  v_mfma_f32_16x16x32_bf16 v[52:55], v[56:59], v[236:239], v[52:55]
  buffer_load_dwordx4 v[160:163], v9, s[48:51], s94 offen offset:2048 nt
  buffer_load_dwordx4 a[124:127], v10, s[56:59], s95 offen offset:256
  v_mov_b32_dpp v4, v26 row_newbcast:12 row_mask:0xf bank_mask:0xf
  v_perm_b32 v56, v4, v4, v16
  v_perm_b32 v57, v4, v4, v17
  v_perm_b32 v58, v4, v4, v18
  v_perm_b32 v59, v4, v4, v19
  s_waitcnt vmcnt(14)
  v_mfma_f32_16x16x32_bf16 v[52:55], v[60:63], v[240:243], v[52:55]
  buffer_load_dwordx4 v[164:167], v9, s[48:51], s94 offen offset:3072 nt
  v_mov_b32_dpp v5, v26 row_newbcast:13 row_mask:0xf bank_mask:0xf
  v_perm_b32 v60, v5, v5, v16
  v_perm_b32 v61, v5, v5, v17
  v_perm_b32 v62, v5, v5, v18
  v_perm_b32 v63, v5, v5, v19
  s_waitcnt vmcnt(14)
  v_mfma_f32_16x16x32_bf16 v[52:55], v[56:59], v[244:247], v[52:55]
  s_xor_b32 s94, s23, 229376
  buffer_load_dwordx4 v[112:115], v9, s[48:51], s94 offen offset:0 nt
  v_mov_b32_dpp v4, v26 row_newbcast:14 row_mask:0xf bank_mask:0xf
  v_perm_b32 v56, v4, v4, v16
  v_perm_b32 v57, v4, v4, v17
  v_perm_b32 v58, v4, v4, v18
  v_perm_b32 v59, v4, v4, v19
  s_waitcnt vmcnt(14)
  v_mfma_f32_16x16x32_bf16 v[52:55], v[60:63], v[248:251], v[52:55]
  buffer_load_dwordx4 v[116:119], v9, s[48:51], s94 offen offset:1024 nt
  v_mov_b32_dpp v5, v26 row_newbcast:15 row_mask:0xf bank_mask:0xf
  v_perm_b32 v60, v5, v5, v16
  v_perm_b32 v61, v5, v5, v17
  v_perm_b32 v62, v5, v5, v18
  v_perm_b32 v63, v5, v5, v19
  s_waitcnt vmcnt(14)
  v_mfma_f32_16x16x32_bf16 v[52:55], v[56:59], v[252:255], v[52:55]
  buffer_load_dwordx4 v[120:123], v9, s[48:51], s94 offen offset:2048 nt
  buffer_load_dwordx4 a[128:131], v10, s[56:59], s95 offen offset:512
  v_mov_b32_dpp v4, v27 row_newbcast:0 row_mask:0xf bank_mask:0xf
  v_perm_b32 v56, v4, v4, v16
  v_perm_b32 v57, v4, v4, v17
  v_perm_b32 v58, v4, v4, v18
  v_perm_b32 v59, v4, v4, v19
  s_waitcnt vmcnt(14)
  v_mfma_f32_16x16x32_bf16 v[52:55], v[60:63], v[132:135], v[52:55]
  buffer_load_dwordx4 v[124:127], v9, s[48:51], s94 offen offset:3072 nt
  v_mov_b32_dpp v5, v27 row_newbcast:1 row_mask:0xf bank_mask:0xf
  v_perm_b32 v60, v5, v5, v16
  v_perm_b32 v61, v5, v5, v17
  v_perm_b32 v62, v5, v5, v18
  v_perm_b32 v63, v5, v5, v19
  s_waitcnt vmcnt(14)
  v_mfma_f32_16x16x32_bf16 v[52:55], v[56:59], v[136:139], v[52:55]
  s_xor_b32 s94, s23, 245760
  buffer_load_dwordx4 v[128:131], v9, s[48:51], s94 offen offset:0 nt
  v_mov_b32_dpp v4, v27 row_newbcast:2 row_mask:0xf bank_mask:0xf
  v_perm_b32 v56, v4, v4, v16
  v_perm_b32 v57, v4, v4, v17
  v_perm_b32 v58, v4, v4, v18
  v_perm_b32 v59, v4, v4, v19
  s_waitcnt vmcnt(14)
  v_mfma_f32_16x16x32_bf16 v[52:55], v[60:63], v[140:143], v[52:55]
  buffer_load_dwordx4 v[168:171], v9, s[48:51], s94 offen offset:1024 nt
  v_mov_b32_dpp v5, v27 row_newbcast:3 row_mask:0xf bank_mask:0xf
  v_perm_b32 v60, v5, v5, v16
  v_perm_b32 v61, v5, v5, v17
  v_perm_b32 v62, v5, v5, v18
  v_perm_b32 v63, v5, v5, v19
  s_waitcnt vmcnt(14)
  v_mfma_f32_16x16x32_bf16 v[52:55], v[56:59], v[144:147], v[52:55]
  buffer_load_dwordx4 v[172:175], v9, s[48:51], s94 offen offset:2048 nt
  buffer_load_dwordx4 a[132:135], v10, s[56:59], s95 offen offset:768
  v_mov_b32_dpp v4, v27 row_newbcast:4 row_mask:0xf bank_mask:0xf
  v_perm_b32 v56, v4, v4, v16
  v_perm_b32 v57, v4, v4, v17
  v_perm_b32 v58, v4, v4, v18
  v_perm_b32 v59, v4, v4, v19
  s_waitcnt vmcnt(14)
  v_mfma_f32_16x16x32_bf16 v[52:55], v[60:63], v[148:151], v[52:55]
  buffer_load_dwordx4 v[176:179], v9, s[48:51], s94 offen offset:3072 nt
  v_mov_b32_dpp v5, v27 row_newbcast:5 row_mask:0xf bank_mask:0xf
  v_perm_b32 v60, v5, v5, v16
  v_perm_b32 v61, v5, v5, v17
  v_perm_b32 v62, v5, v5, v18
  v_perm_b32 v63, v5, v5, v19
  s_waitcnt vmcnt(14)
  v_mfma_f32_16x16x32_bf16 v[52:55], v[56:59], v[152:155], v[52:55]
  s_xor_b32 s94, s23, 262144
  buffer_load_dwordx4 v[180:183], v9, s[48:51], s94 offen offset:0 nt
  v_mov_b32_dpp v4, v27 row_newbcast:6 row_mask:0xf bank_mask:0xf
  v_perm_b32 v56, v4, v4, v16
  v_perm_b32 v57, v4, v4, v17
  v_perm_b32 v58, v4, v4, v18
  v_perm_b32 v59, v4, v4, v19
  s_waitcnt vmcnt(14)
  v_mfma_f32_16x16x32_bf16 v[52:55], v[60:63], v[156:159], v[52:55]
  buffer_load_dwordx4 v[184:187], v9, s[48:51], s94 offen offset:1024 nt
  v_mov_b32_dpp v5, v27 row_newbcast:7 row_mask:0xf bank_mask:0xf
  v_perm_b32 v60, v5, v5, v16
  v_perm_b32 v61, v5, v5, v17
  v_perm_b32 v62, v5, v5, v18
  v_perm_b32 v63, v5, v5, v19
  s_waitcnt vmcnt(14)
  v_mfma_f32_16x16x32_bf16 v[52:55], v[56:59], v[160:163], v[52:55]
  buffer_load_dwordx4 v[188:191], v9, s[48:51], s94 offen offset:2048 nt
  buffer_load_dwordx4 a[136:139], v10, s[56:59], s95 offen offset:1024
  v_mov_b32_dpp v4, v27 row_newbcast:8 row_mask:0xf bank_mask:0xf
  v_perm_b32 v56, v4, v4, v16
  v_perm_b32 v57, v4, v4, v17
  v_perm_b32 v58, v4, v4, v18
  v_perm_b32 v59, v4, v4, v19
  s_waitcnt vmcnt(14)
  v_mfma_f32_16x16x32_bf16 v[52:55], v[60:63], v[164:167], v[52:55]
  buffer_load_dwordx4 v[192:195], v9, s[48:51], s94 offen offset:3072 nt
  v_mov_b32_dpp v5, v27 row_newbcast:9 row_mask:0xf bank_mask:0xf
  v_perm_b32 v60, v5, v5, v16
  v_perm_b32 v61, v5, v5, v17
  v_perm_b32 v62, v5, v5, v18
  v_perm_b32 v63, v5, v5, v19
  s_waitcnt vmcnt(14)
  v_mfma_f32_16x16x32_bf16 v[52:55], v[56:59], v[112:115], v[52:55]
  s_xor_b32 s94, s23, 278528
  buffer_load_dwordx4 v[196:199], v9, s[48:51], s94 offen offset:0 nt
  v_mov_b32_dpp v4, v27 row_newbcast:10 row_mask:0xf bank_mask:0xf
  v_perm_b32 v56, v4, v4, v16
  v_perm_b32 v57, v4, v4, v17
  v_perm_b32 v58, v4, v4, v18
  v_perm_b32 v59, v4, v4, v19
  s_waitcnt vmcnt(14)
  v_mfma_f32_16x16x32_bf16 v[52:55], v[60:63], v[116:119], v[52:55]
  buffer_load_dwordx4 v[200:203], v9, s[48:51], s94 offen offset:1024 nt
  v_mov_b32_dpp v5, v27 row_newbcast:11 row_mask:0xf bank_mask:0xf
  v_perm_b32 v60, v5, v5, v16
  v_perm_b32 v61, v5, v5, v17
  v_perm_b32 v62, v5, v5, v18
  v_perm_b32 v63, v5, v5, v19
  s_waitcnt vmcnt(14)
  v_mfma_f32_16x16x32_bf16 v[52:55], v[56:59], v[120:123], v[52:55]
  buffer_load_dwordx4 v[204:207], v9, s[48:51], s94 offen offset:2048 nt
  buffer_load_dwordx4 a[140:143], v10, s[56:59], s95 offen offset:1280
  v_mov_b32_dpp v4, v27 row_newbcast:12 row_mask:0xf bank_mask:0xf
  v_perm_b32 v56, v4, v4, v16
  v_perm_b32 v57, v4, v4, v17
  v_perm_b32 v58, v4, v4, v18
  v_perm_b32 v59, v4, v4, v19
  s_waitcnt vmcnt(14)
  v_mfma_f32_16x16x32_bf16 v[52:55], v[60:63], v[124:127], v[52:55]
  buffer_load_dwordx4 v[208:211], v9, s[48:51], s94 offen offset:3072 nt
  v_mov_b32_dpp v5, v27 row_newbcast:13 row_mask:0xf bank_mask:0xf
  v_perm_b32 v60, v5, v5, v16
  v_perm_b32 v61, v5, v5, v17
  v_perm_b32 v62, v5, v5, v18
  v_perm_b32 v63, v5, v5, v19
  s_waitcnt vmcnt(14)
  v_mfma_f32_16x16x32_bf16 v[52:55], v[56:59], v[128:131], v[52:55]
  s_xor_b32 s94, s23, 294912
  buffer_load_dwordx4 v[212:215], v9, s[48:51], s94 offen offset:0 nt
  v_mov_b32_dpp v4, v27 row_newbcast:14 row_mask:0xf bank_mask:0xf
  v_perm_b32 v56, v4, v4, v16
  v_perm_b32 v57, v4, v4, v17
  v_perm_b32 v58, v4, v4, v18
  v_perm_b32 v59, v4, v4, v19
  s_waitcnt vmcnt(14)
  v_mfma_f32_16x16x32_bf16 v[52:55], v[60:63], v[168:171], v[52:55]
  buffer_load_dwordx4 v[216:219], v9, s[48:51], s94 offen offset:1024 nt
  v_mov_b32_dpp v5, v27 row_newbcast:15 row_mask:0xf bank_mask:0xf
  v_perm_b32 v60, v5, v5, v16
  v_perm_b32 v61, v5, v5, v17
  v_perm_b32 v62, v5, v5, v18
  v_perm_b32 v63, v5, v5, v19
  s_waitcnt vmcnt(14)
  v_mfma_f32_16x16x32_bf16 v[52:55], v[56:59], v[172:175], v[52:55]
  buffer_load_dwordx4 v[220:223], v9, s[48:51], s94 offen offset:2048 nt
  buffer_load_dwordx4 a[144:147], v10, s[56:59], s95 offen offset:1536
  v_mov_b32_dpp v4, v28 row_newbcast:0 row_mask:0xf bank_mask:0xf
  v_perm_b32 v56, v4, v4, v16
  v_perm_b32 v57, v4, v4, v17
  v_perm_b32 v58, v4, v4, v18
  v_perm_b32 v59, v4, v4, v19
  s_waitcnt vmcnt(14)
  v_mfma_f32_16x16x32_bf16 v[52:55], v[60:63], v[176:179], v[52:55]
  buffer_load_dwordx4 v[224:227], v9, s[48:51], s94 offen offset:3072 nt
  v_mov_b32_dpp v5, v28 row_newbcast:1 row_mask:0xf bank_mask:0xf
  v_perm_b32 v60, v5, v5, v16
  v_perm_b32 v61, v5, v5, v17
  v_perm_b32 v62, v5, v5, v18
  v_perm_b32 v63, v5, v5, v19
  s_waitcnt vmcnt(14)
  v_mfma_f32_16x16x32_bf16 v[52:55], v[56:59], v[180:183], v[52:55]
  s_xor_b32 s94, s23, 311296
  buffer_load_dwordx4 v[228:231], v9, s[48:51], s94 offen offset:0 nt
  s_cmp_eq_u32 s3, 0
  s_cbranch_scc0 L_w0_pi
  buffer_load_dwordx4 v[72:75], v8, s[76:79], 0 offen sc1
  buffer_load_dwordx4 v[76:79], v8, s[76:79], s30 offen sc1
  buffer_load_dwordx2 v[90:91], v85, s[76:79], 0 offen sc1
L_w0_pi:
  v_mov_b32_dpp v4, v28 row_newbcast:2 row_mask:0xf bank_mask:0xf
  v_perm_b32 v56, v4, v4, v16
  v_perm_b32 v57, v4, v4, v17
  v_perm_b32 v58, v4, v4, v18
  v_perm_b32 v59, v4, v4, v19
  s_waitcnt vmcnt(14)
  v_mfma_f32_16x16x32_bf16 v[52:55], v[60:63], v[184:187], v[52:55]
  buffer_load_dwordx4 v[232:235], v9, s[48:51], s94 offen offset:1024 nt
  v_mov_b32_dpp v5, v28 row_newbcast:3 row_mask:0xf bank_mask:0xf
  v_perm_b32 v60, v5, v5, v16
  v_perm_b32 v61, v5, v5, v17
  v_perm_b32 v62, v5, v5, v18
  v_perm_b32 v63, v5, v5, v19
  s_waitcnt vmcnt(14)
  v_mfma_f32_16x16x32_bf16 v[52:55], v[56:59], v[188:191], v[52:55]
  buffer_load_dwordx4 v[236:239], v9, s[48:51], s94 offen offset:2048 nt
  buffer_load_dwordx4 a[148:151], v10, s[56:59], s95 offen offset:1792
  v_mov_b32_dpp v4, v28 row_newbcast:4 row_mask:0xf bank_mask:0xf
  v_perm_b32 v56, v4, v4, v16
  v_perm_b32 v57, v4, v4, v17
  v_perm_b32 v58, v4, v4, v18
  v_perm_b32 v59, v4, v4, v19
  s_waitcnt vmcnt(14)
  v_mfma_f32_16x16x32_bf16 v[52:55], v[60:63], v[192:195], v[52:55]
  buffer_load_dwordx4 v[240:243], v9, s[48:51], s94 offen offset:3072 nt
  v_mov_b32_dpp v5, v28 row_newbcast:5 row_mask:0xf bank_mask:0xf
  v_perm_b32 v60, v5, v5, v16
  v_perm_b32 v61, v5, v5, v17
  v_perm_b32 v62, v5, v5, v18
  v_perm_b32 v63, v5, v5, v19
  s_waitcnt vmcnt(14)
  v_mfma_f32_16x16x32_bf16 v[52:55], v[56:59], v[196:199], v[52:55]
  s_xor_b32 s94, s23, 327680
  buffer_load_dwordx4 v[244:247], v9, s[48:51], s94 offen offset:0 nt
  v_mov_b32_dpp v4, v28 row_newbcast:6 row_mask:0xf bank_mask:0xf
  v_perm_b32 v56, v4, v4, v16
  v_perm_b32 v57, v4, v4, v17
  v_perm_b32 v58, v4, v4, v18
  v_perm_b32 v59, v4, v4, v19
  s_waitcnt vmcnt(14)
  v_mfma_f32_16x16x32_bf16 v[52:55], v[60:63], v[200:203], v[52:55]
  buffer_load_dwordx4 v[248:251], v9, s[48:51], s94 offen offset:1024 nt
  v_mov_b32_dpp v5, v28 row_newbcast:7 row_mask:0xf bank_mask:0xf
  v_perm_b32 v60, v5, v5, v16
  v_perm_b32 v61, v5, v5, v17
  v_perm_b32 v62, v5, v5, v18
  v_perm_b32 v63, v5, v5, v19
  s_waitcnt vmcnt(14)
  v_mfma_f32_16x16x32_bf16 v[52:55], v[56:59], v[204:207], v[52:55]
  buffer_load_dwordx4 v[252:255], v9, s[48:51], s94 offen offset:2048 nt
  buffer_load_dwordx4 a[152:155], v10, s[56:59], s95 offen offset:2048
  v_mov_b32_dpp v4, v28 row_newbcast:8 row_mask:0xf bank_mask:0xf
  v_perm_b32 v56, v4, v4, v16
  v_perm_b32 v57, v4, v4, v17
  v_perm_b32 v58, v4, v4, v18
  v_perm_b32 v59, v4, v4, v19
  s_waitcnt vmcnt(14)
  v_mfma_f32_16x16x32_bf16 v[52:55], v[60:63], v[208:211], v[52:55]
  buffer_load_dwordx4 v[132:135], v9, s[48:51], s94 offen offset:3072 nt
  v_mov_b32_dpp v5, v28 row_newbcast:9 row_mask:0xf bank_mask:0xf
  v_perm_b32 v60, v5, v5, v16
  v_perm_b32 v61, v5, v5, v17
  v_perm_b32 v62, v5, v5, v18
  v_perm_b32 v63, v5, v5, v19
  s_waitcnt vmcnt(14)
  v_mfma_f32_16x16x32_bf16 v[52:55], v[56:59], v[212:215], v[52:55]
  s_xor_b32 s94, s23, 344064
  buffer_load_dwordx4 v[136:139], v9, s[48:51], s94 offen offset:0 nt
  v_mov_b32_dpp v4, v28 row_newbcast:10 row_mask:0xf bank_mask:0xf
  v_perm_b32 v56, v4, v4, v16
  v_perm_b32 v57, v4, v4, v17
  v_perm_b32 v58, v4, v4, v18
  v_perm_b32 v59, v4, v4, v19
  s_waitcnt vmcnt(14)
  v_mfma_f32_16x16x32_bf16 v[52:55], v[60:63], v[216:219], v[52:55]
  buffer_load_dwordx4 v[140:143], v9, s[48:51], s94 offen offset:1024 nt
  v_mov_b32_dpp v5, v28 row_newbcast:11 row_mask:0xf bank_mask:0xf
  v_perm_b32 v60, v5, v5, v16
  v_perm_b32 v61, v5, v5, v17
  v_perm_b32 v62, v5, v5, v18
  v_perm_b32 v63, v5, v5, v19
  s_waitcnt vmcnt(14)
  v_mfma_f32_16x16x32_bf16 v[52:55], v[56:59], v[220:223], v[52:55]
  buffer_load_dwordx4 v[144:147], v9, s[48:51], s94 offen offset:2048 nt
  buffer_load_dwordx4 a[156:159], v10, s[56:59], s95 offen offset:2304
  v_mov_b32_dpp v4, v28 row_newbcast:12 row_mask:0xf bank_mask:0xf
  v_perm_b32 v56, v4, v4, v16
  v_perm_b32 v57, v4, v4, v17
  v_perm_b32 v58, v4, v4, v18
  v_perm_b32 v59, v4, v4, v19
  s_waitcnt vmcnt(14)
  v_mfma_f32_16x16x32_bf16 v[52:55], v[60:63], v[224:227], v[52:55]
  buffer_load_dwordx4 v[148:151], v9, s[48:51], s94 offen offset:3072 nt
  v_mov_b32_dpp v5, v28 row_newbcast:13 row_mask:0xf bank_mask:0xf
  v_perm_b32 v60, v5, v5, v16
  v_perm_b32 v61, v5, v5, v17
  v_perm_b32 v62, v5, v5, v18
  v_perm_b32 v63, v5, v5, v19
  s_waitcnt vmcnt(14)
  v_mfma_f32_16x16x32_bf16 v[52:55], v[56:59], v[228:231], v[52:55]
  s_xor_b32 s94, s23, 360448
  buffer_load_dwordx4 v[152:155], v9, s[48:51], s94 offen offset:0 nt
  v_mov_b32_dpp v4, v28 row_newbcast:14 row_mask:0xf bank_mask:0xf
  v_perm_b32 v56, v4, v4, v16
  v_perm_b32 v57, v4, v4, v17
  v_perm_b32 v58, v4, v4, v18
  v_perm_b32 v59, v4, v4, v19
  s_waitcnt vmcnt(14)
  v_mfma_f32_16x16x32_bf16 v[52:55], v[60:63], v[232:235], v[52:55]
  buffer_load_dwordx4 v[156:159], v9, s[48:51], s94 offen offset:1024 nt
  v_mov_b32_dpp v5, v28 row_newbcast:15 row_mask:0xf bank_mask:0xf
  v_perm_b32 v60, v5, v5, v16
  v_perm_b32 v61, v5, v5, v17
  v_perm_b32 v62, v5, v5, v18
  v_perm_b32 v63, v5, v5, v19
  s_waitcnt vmcnt(14)
  v_mfma_f32_16x16x32_bf16 v[52:55], v[56:59], v[236:239], v[52:55]
  buffer_load_dwordx4 v[160:163], v9, s[48:51], s94 offen offset:2048 nt
  v_mov_b32_dpp v4, v29 row_newbcast:0 row_mask:0xf bank_mask:0xf
  v_perm_b32 v56, v4, v4, v16
  v_perm_b32 v57, v4, v4, v17
  v_perm_b32 v58, v4, v4, v18
  v_perm_b32 v59, v4, v4, v19
  s_waitcnt vmcnt(13)
  v_mfma_f32_16x16x32_bf16 v[52:55], v[60:63], v[240:243], v[52:55]
  buffer_load_dwordx4 v[164:167], v9, s[48:51], s94 offen offset:3072 nt
  v_mov_b32_dpp v5, v29 row_newbcast:1 row_mask:0xf bank_mask:0xf
  v_perm_b32 v60, v5, v5, v16
  v_perm_b32 v61, v5, v5, v17
  v_perm_b32 v62, v5, v5, v18
  v_perm_b32 v63, v5, v5, v19
  s_waitcnt vmcnt(13)
  v_mfma_f32_16x16x32_bf16 v[52:55], v[56:59], v[244:247], v[52:55]
  s_xor_b32 s94, s23, 376832
  buffer_load_dwordx4 v[112:115], v9, s[48:51], s94 offen offset:0 nt
  v_mov_b32_dpp v4, v29 row_newbcast:2 row_mask:0xf bank_mask:0xf
  v_perm_b32 v56, v4, v4, v16
  v_perm_b32 v57, v4, v4, v17
  v_perm_b32 v58, v4, v4, v18
  v_perm_b32 v59, v4, v4, v19
  s_waitcnt vmcnt(13)
  v_mfma_f32_16x16x32_bf16 v[52:55], v[60:63], v[248:251], v[52:55]
  buffer_load_dwordx4 v[116:119], v9, s[48:51], s94 offen offset:1024 nt
  v_mov_b32_dpp v5, v29 row_newbcast:3 row_mask:0xf bank_mask:0xf
  v_perm_b32 v60, v5, v5, v16
  v_perm_b32 v61, v5, v5, v17
  v_perm_b32 v62, v5, v5, v18
  v_perm_b32 v63, v5, v5, v19
  s_waitcnt vmcnt(13)
  v_mfma_f32_16x16x32_bf16 v[52:55], v[56:59], v[252:255], v[52:55]
  buffer_load_dwordx4 v[120:123], v9, s[48:51], s94 offen offset:2048 nt
  v_mov_b32_dpp v4, v29 row_newbcast:4 row_mask:0xf bank_mask:0xf
  v_perm_b32 v56, v4, v4, v16
  v_perm_b32 v57, v4, v4, v17
  v_perm_b32 v58, v4, v4, v18
  v_perm_b32 v59, v4, v4, v19
  s_waitcnt vmcnt(12)
  v_mfma_f32_16x16x32_bf16 v[52:55], v[60:63], v[132:135], v[52:55]
  buffer_load_dwordx4 v[124:127], v9, s[48:51], s94 offen offset:3072 nt
  v_mov_b32_dpp v5, v29 row_newbcast:5 row_mask:0xf bank_mask:0xf
  v_perm_b32 v60, v5, v5, v16
  v_perm_b32 v61, v5, v5, v17
  v_perm_b32 v62, v5, v5, v18
  v_perm_b32 v63, v5, v5, v19
  s_waitcnt vmcnt(12)
  v_mfma_f32_16x16x32_bf16 v[52:55], v[56:59], v[136:139], v[52:55]
  s_xor_b32 s94, s23, 393216
  buffer_load_dwordx4 v[128:131], v9, s[48:51], s94 offen offset:0 nt
  v_mov_b32_dpp v4, v29 row_newbcast:6 row_mask:0xf bank_mask:0xf
  v_perm_b32 v56, v4, v4, v16
  v_perm_b32 v57, v4, v4, v17
  v_perm_b32 v58, v4, v4, v18
  v_perm_b32 v59, v4, v4, v19
  s_waitcnt vmcnt(12)
  v_mfma_f32_16x16x32_bf16 v[52:55], v[60:63], v[140:143], v[52:55]
  buffer_load_dwordx4 v[168:171], v9, s[48:51], s94 offen offset:1024 nt
  v_mov_b32_dpp v5, v29 row_newbcast:7 row_mask:0xf bank_mask:0xf
  v_perm_b32 v60, v5, v5, v16
  v_perm_b32 v61, v5, v5, v17
  v_perm_b32 v62, v5, v5, v18
  v_perm_b32 v63, v5, v5, v19
  s_waitcnt vmcnt(12)
  v_mfma_f32_16x16x32_bf16 v[52:55], v[56:59], v[144:147], v[52:55]
  buffer_load_dwordx4 v[172:175], v9, s[48:51], s94 offen offset:2048 nt
  v_mov_b32_dpp v4, v29 row_newbcast:8 row_mask:0xf bank_mask:0xf
  v_perm_b32 v56, v4, v4, v16
  v_perm_b32 v57, v4, v4, v17
  v_perm_b32 v58, v4, v4, v18
  v_perm_b32 v59, v4, v4, v19
  s_waitcnt vmcnt(11)
  v_mfma_f32_16x16x32_bf16 v[52:55], v[60:63], v[148:151], v[52:55]
  buffer_load_dwordx4 v[176:179], v9, s[48:51], s94 offen offset:3072 nt
  v_mov_b32_dpp v5, v29 row_newbcast:9 row_mask:0xf bank_mask:0xf
  v_perm_b32 v60, v5, v5, v16
  v_perm_b32 v61, v5, v5, v17
  v_perm_b32 v62, v5, v5, v18
  v_perm_b32 v63, v5, v5, v19
  s_waitcnt vmcnt(11)
  v_mfma_f32_16x16x32_bf16 v[52:55], v[56:59], v[152:155], v[52:55]
  s_xor_b32 s94, s23, 409600
  buffer_load_dwordx4 v[180:183], v9, s[48:51], s94 offen offset:0 nt
  v_mov_b32_dpp v4, v29 row_newbcast:10 row_mask:0xf bank_mask:0xf
  v_perm_b32 v56, v4, v4, v16
  v_perm_b32 v57, v4, v4, v17
  v_perm_b32 v58, v4, v4, v18
  v_perm_b32 v59, v4, v4, v19
  s_waitcnt vmcnt(11)
  v_mfma_f32_16x16x32_bf16 v[52:55], v[60:63], v[156:159], v[52:55]
  buffer_load_dwordx4 v[184:187], v9, s[48:51], s94 offen offset:1024 nt
  v_mov_b32_dpp v5, v29 row_newbcast:11 row_mask:0xf bank_mask:0xf
  v_perm_b32 v60, v5, v5, v16
  v_perm_b32 v61, v5, v5, v17
  v_perm_b32 v62, v5, v5, v18
  v_perm_b32 v63, v5, v5, v19
  s_waitcnt vmcnt(11)
  v_mfma_f32_16x16x32_bf16 v[52:55], v[56:59], v[160:163], v[52:55]
  buffer_load_dwordx4 v[188:191], v9, s[48:51], s94 offen offset:2048 nt
  s_cmp_eq_u32 s3, 0
  s_cbranch_scc0 L_w0_pu
  v_max3_u32 v92, v72, v73, v74
  v_max3_u32 v93, v75, v76, v77
  v_max3_u32 v92, v92, v78, v79
  v_max3_u32 v93, v93, v90, v91
  v_max_u32 v92, v92, v93
  v_cmp_eq_u32 vcc, -1, v92
  s_nop 0
  s_cmp_eq_u64 vcc, 0
  s_cbranch_scc0 L_slow_p
L_ok_p:
  v_mov_b32 v92, v90
  v_pk_add_f32 v[72:73], v[72:73], v[76:77]
  v_pk_add_f32 v[74:75], v[74:75], v[78:79]
  v_max_f32_dpp v92, v92, v92 quad_perm:[1,0,3,2] row_mask:0xf bank_mask:0xf
  s_nop 1
  v_max_f32_dpp v92, v92, v92 quad_perm:[2,3,0,1] row_mask:0xf bank_mask:0xf
  s_nop 1
  v_max_f32_dpp v92, v92, v92 row_half_mirror row_mask:0xf bank_mask:0xf
  s_nop 1
  v_max_f32_dpp v92, v92, v92 row_ror:8 row_mask:0xf bank_mask:0xf
  v_add_f32_dpp v72, v72, v72 row_ror:8 row_mask:0xf bank_mask:0xf
  v_add_f32_dpp v73, v73, v73 row_ror:8 row_mask:0xf bank_mask:0xf
  v_add_f32_dpp v74, v74, v74 row_ror:8 row_mask:0xf bank_mask:0xf
  v_add_f32_dpp v75, v75, v75 row_ror:8 row_mask:0xf bank_mask:0xf
  v_sub_f32 v90, v90, v92
  v_mul_f32 v90, 0x3fb8aa3b, v90
  v_exp_f32 v90, v90
  v_permlane16_swap_b32 v72, v73
  v_permlane16_swap_b32 v74, v75
  v_mul_f32 v90, v90, v91
  v_add_f32 v72, v72, v73
  v_add_f32 v74, v74, v75
  v_add_f32_dpp v90, v90, v90 quad_perm:[1,0,3,2] row_mask:0xf bank_mask:0xf
  s_nop 1
  v_add_f32_dpp v90, v90, v90 quad_perm:[2,3,0,1] row_mask:0xf bank_mask:0xf
  s_nop 1
  v_add_f32_dpp v90, v90, v90 row_half_mirror row_mask:0xf bank_mask:0xf
  s_nop 1
  v_add_f32_dpp v90, v90, v90 row_ror:8 row_mask:0xf bank_mask:0xf
  v_permlane32_swap_b32 v72, v74
  v_rcp_f32 v93, v90
  v_add_f32 v72, v72, v74
  ds_write_b32 v100, v72 offset:16128
  v_mov_b32 v94, 0
  ds_write_b64 v94, v[92:93] offset:16256
  s_waitcnt lgkmcnt(0)
L_w0_pu:
  s_lshl_b32 s8, s3, 4
  v_lshlrev_b32 v94, 2, v2
  v_add_u32 v94, s8, v94
  v_mov_b32 v95, 0
  s_barrier
  ds_read_b32 v92, v94 offset:16128
  ds_read_b32 v93, v94 offset:16192
  ds_read_b64 v[90:91], v95 offset:16256
  v_mov_b32_dpp v4, v29 row_newbcast:12 row_mask:0xf bank_mask:0xf
  v_perm_b32 v56, v4, v4, v16
  v_perm_b32 v57, v4, v4, v17
  v_perm_b32 v58, v4, v4, v18
  v_perm_b32 v59, v4, v4, v19
  s_waitcnt vmcnt(11)
  v_mfma_f32_16x16x32_bf16 v[52:55], v[60:63], v[164:167], v[52:55]
  buffer_load_dwordx4 v[192:195], v9, s[48:51], s94 offen offset:3072 nt
  v_mov_b32_dpp v5, v29 row_newbcast:13 row_mask:0xf bank_mask:0xf
  v_perm_b32 v60, v5, v5, v16
  v_perm_b32 v61, v5, v5, v17
  v_perm_b32 v62, v5, v5, v18
  v_perm_b32 v63, v5, v5, v19
  s_waitcnt vmcnt(11)
  v_mfma_f32_16x16x32_bf16 v[52:55], v[56:59], v[112:115], v[52:55]
  s_xor_b32 s94, s23, 425984
  buffer_load_dwordx4 v[196:199], v9, s[48:51], s94 offen offset:0 nt
  s_waitcnt lgkmcnt(0)
  v_sub_f32 v83, v81, v90
  v_mul_f32 v83, 0x3fb8aa3b, v83
  v_exp_f32 v83, v83
  v_mul_f32 v91, v91, v80
  v_mul_f32 v83, v83, v91
  v_cvt_pk_bf16_f32 v68, v92, v93
  v_lshlrev_b32 v92, 16, v68
  v_and_b32 v93, 0xffff0000, v68
  v_mul_f32 v68, v92, v92
  v_mul_f32 v68, 0x3d372713, v68
  v_fma_f32 v68, v68, v92, v92
  v_mul_f32 v68, 0xc0135761, v68
  v_exp_f32 v68, v68
  s_nop 0
  v_add_f32 v68, 1.0, v68
  v_rcp_f32 v68, v68
  s_nop 0
  v_mul_f32 v92, v92, v68
  v_cvt_pk_bf16_f32 v92, v92, v92
  v_lshlrev_b32 v92, 16, v92
  v_mul_f32 v92, v92, v93
  v_cvt_pk_bf16_f32 v92, v92, v92
  v_lshlrev_b32 v92, 16, v92
  v_mul_f32 v92, v92, v87
  v_cvt_pk_bf16_f32 v68, v92, v92
  v_lshlrev_b32 v68, 16, v68
  v_sub_f32 v68, v92, v68
  v_cvt_pk_bf16_f32 v92, v92, v68
  v_perm_b32 v64, v92, v92, v16
  v_perm_b32 v65, v92, v92, v17
  v_perm_b32 v66, v92, v92, v18
  v_perm_b32 v67, v92, v92, v19
  s_nop 1
  v_mfma_f32_16x16x32_bf16 v[32:35], v[64:67], a[160:163], 0
  v_mfma_f32_16x16x32_bf16 v[36:39], v[64:67], a[164:167], 0
  v_mfma_f32_16x16x32_bf16 v[40:43], v[64:67], a[168:171], 0
  v_mfma_f32_16x16x32_bf16 v[44:47], v[64:67], a[172:175], 0
  v_mfma_f32_16x16x32_bf16 v[48:51], v[64:67], a[176:179], 0
  v_mov_b32_dpp v4, v29 row_newbcast:14 row_mask:0xf bank_mask:0xf
  v_perm_b32 v56, v4, v4, v16
  v_perm_b32 v57, v4, v4, v17
  v_perm_b32 v58, v4, v4, v18
  v_perm_b32 v59, v4, v4, v19
  s_waitcnt vmcnt(11)
  v_mfma_f32_16x16x32_bf16 v[52:55], v[60:63], v[116:119], v[52:55]
  buffer_load_dwordx4 v[200:203], v9, s[48:51], s94 offen offset:1024 nt
  v_mov_b32_dpp v5, v29 row_newbcast:15 row_mask:0xf bank_mask:0xf
  v_perm_b32 v60, v5, v5, v16
  v_perm_b32 v61, v5, v5, v17
  v_perm_b32 v62, v5, v5, v18
  v_perm_b32 v63, v5, v5, v19
  s_waitcnt vmcnt(11)
  v_mfma_f32_16x16x32_bf16 v[52:55], v[56:59], v[120:123], v[52:55]
  buffer_load_dwordx4 v[204:207], v9, s[48:51], s94 offen offset:2048 nt
  v_mov_b32_dpp v4, v30 row_newbcast:0 row_mask:0xf bank_mask:0xf
  v_perm_b32 v56, v4, v4, v16
  v_perm_b32 v57, v4, v4, v17
  v_perm_b32 v58, v4, v4, v18
  v_perm_b32 v59, v4, v4, v19
  s_waitcnt vmcnt(11)
  v_mfma_f32_16x16x32_bf16 v[52:55], v[60:63], v[124:127], v[52:55]
  buffer_load_dwordx4 v[208:211], v9, s[48:51], s94 offen offset:3072 nt
  v_mov_b32_dpp v5, v30 row_newbcast:1 row_mask:0xf bank_mask:0xf
  v_perm_b32 v60, v5, v5, v16
  v_perm_b32 v61, v5, v5, v17
  v_perm_b32 v62, v5, v5, v18
  v_perm_b32 v63, v5, v5, v19
  s_waitcnt vmcnt(11)
  v_mfma_f32_16x16x32_bf16 v[52:55], v[56:59], v[128:131], v[52:55]
  s_xor_b32 s94, s23, 442368
  buffer_load_dwordx4 v[212:215], v9, s[48:51], s94 offen offset:0 nt
  v_mov_b32_dpp v4, v30 row_newbcast:2 row_mask:0xf bank_mask:0xf
  v_perm_b32 v56, v4, v4, v16
  v_perm_b32 v57, v4, v4, v17
  v_perm_b32 v58, v4, v4, v18
  v_perm_b32 v59, v4, v4, v19
  s_waitcnt vmcnt(11)
  v_mfma_f32_16x16x32_bf16 v[52:55], v[60:63], v[168:171], v[52:55]
  buffer_load_dwordx4 v[216:219], v9, s[48:51], s94 offen offset:1024 nt
  v_mov_b32_dpp v5, v30 row_newbcast:3 row_mask:0xf bank_mask:0xf
  v_perm_b32 v60, v5, v5, v16
  v_perm_b32 v61, v5, v5, v17
  v_perm_b32 v62, v5, v5, v18
  v_perm_b32 v63, v5, v5, v19
  s_waitcnt vmcnt(11)
  v_mfma_f32_16x16x32_bf16 v[52:55], v[56:59], v[172:175], v[52:55]
  buffer_load_dwordx4 v[220:223], v9, s[48:51], s94 offen offset:2048 nt
  v_mov_b32_dpp v4, v30 row_newbcast:4 row_mask:0xf bank_mask:0xf
  v_perm_b32 v56, v4, v4, v16
  v_perm_b32 v57, v4, v4, v17
  v_perm_b32 v58, v4, v4, v18
  v_perm_b32 v59, v4, v4, v19
  s_waitcnt vmcnt(11)
  v_mfma_f32_16x16x32_bf16 v[52:55], v[60:63], v[176:179], v[52:55]
  buffer_load_dwordx4 v[224:227], v9, s[48:51], s94 offen offset:3072 nt
  v_mov_b32_dpp v5, v30 row_newbcast:5 row_mask:0xf bank_mask:0xf
  v_perm_b32 v60, v5, v5, v16
  v_perm_b32 v61, v5, v5, v17
  v_perm_b32 v62, v5, v5, v18
  v_perm_b32 v63, v5, v5, v19
  s_waitcnt vmcnt(11)
  v_mfma_f32_16x16x32_bf16 v[52:55], v[56:59], v[180:183], v[52:55]
  s_xor_b32 s94, s23, 458752
  buffer_load_dwordx4 v[228:231], v9, s[48:51], s94 offen offset:0 nt
  v_mov_b32_dpp v4, v30 row_newbcast:6 row_mask:0xf bank_mask:0xf
  v_perm_b32 v56, v4, v4, v16
  v_perm_b32 v57, v4, v4, v17
  v_perm_b32 v58, v4, v4, v18
  v_perm_b32 v59, v4, v4, v19
  s_waitcnt vmcnt(11)
  v_mfma_f32_16x16x32_bf16 v[52:55], v[60:63], v[184:187], v[52:55]
  buffer_load_dwordx4 v[232:235], v9, s[48:51], s94 offen offset:1024 nt
  v_mov_b32_dpp v5, v30 row_newbcast:7 row_mask:0xf bank_mask:0xf
  v_perm_b32 v60, v5, v5, v16
  v_perm_b32 v61, v5, v5, v17
  v_perm_b32 v62, v5, v5, v18
  v_perm_b32 v63, v5, v5, v19
  s_waitcnt vmcnt(11)
  v_mfma_f32_16x16x32_bf16 v[52:55], v[56:59], v[188:191], v[52:55]
  buffer_load_dwordx4 v[236:239], v9, s[48:51], s94 offen offset:2048 nt
  v_mov_b32_dpp v4, v30 row_newbcast:8 row_mask:0xf bank_mask:0xf
  v_perm_b32 v56, v4, v4, v16
  v_perm_b32 v57, v4, v4, v17
  v_perm_b32 v58, v4, v4, v18
  v_perm_b32 v59, v4, v4, v19
  s_waitcnt vmcnt(11)
  v_mfma_f32_16x16x32_bf16 v[52:55], v[60:63], v[192:195], v[52:55]
  buffer_load_dwordx4 v[240:243], v9, s[48:51], s94 offen offset:3072 nt
  v_mov_b32_dpp v5, v30 row_newbcast:9 row_mask:0xf bank_mask:0xf
  v_perm_b32 v60, v5, v5, v16
  v_perm_b32 v61, v5, v5, v17
  v_perm_b32 v62, v5, v5, v18
  v_perm_b32 v63, v5, v5, v19
  s_waitcnt vmcnt(11)
  v_mfma_f32_16x16x32_bf16 v[52:55], v[56:59], v[196:199], v[52:55]
  s_xor_b32 s94, s23, 475136
  buffer_load_dwordx4 v[244:247], v9, s[48:51], s94 offen offset:0 nt
  v_mov_b32_dpp v4, v30 row_newbcast:10 row_mask:0xf bank_mask:0xf
  v_perm_b32 v56, v4, v4, v16
  v_perm_b32 v57, v4, v4, v17
  v_perm_b32 v58, v4, v4, v18
  v_perm_b32 v59, v4, v4, v19
  s_waitcnt vmcnt(11)
  v_mfma_f32_16x16x32_bf16 v[52:55], v[60:63], v[200:203], v[52:55]
  buffer_load_dwordx4 v[248:251], v9, s[48:51], s94 offen offset:1024 nt
  v_mov_b32_dpp v5, v30 row_newbcast:11 row_mask:0xf bank_mask:0xf
  v_perm_b32 v60, v5, v5, v16
  v_perm_b32 v61, v5, v5, v17
  v_perm_b32 v62, v5, v5, v18
  v_perm_b32 v63, v5, v5, v19
  s_waitcnt vmcnt(11)
  v_mfma_f32_16x16x32_bf16 v[52:55], v[56:59], v[204:207], v[52:55]
  buffer_load_dwordx4 v[252:255], v9, s[48:51], s94 offen offset:2048 nt
  v_mov_b32_dpp v4, v30 row_newbcast:12 row_mask:0xf bank_mask:0xf
  v_perm_b32 v56, v4, v4, v16
  v_perm_b32 v57, v4, v4, v17
  v_perm_b32 v58, v4, v4, v18
  v_perm_b32 v59, v4, v4, v19
  s_waitcnt vmcnt(11)
  v_mfma_f32_16x16x32_bf16 v[52:55], v[60:63], v[208:211], v[52:55]
  buffer_load_dwordx4 v[132:135], v9, s[48:51], s94 offen offset:3072 nt
  v_mov_b32_dpp v5, v30 row_newbcast:13 row_mask:0xf bank_mask:0xf
  v_perm_b32 v60, v5, v5, v16
  v_perm_b32 v61, v5, v5, v17
  v_perm_b32 v62, v5, v5, v18
  v_perm_b32 v63, v5, v5, v19
  s_waitcnt vmcnt(11)
  v_mfma_f32_16x16x32_bf16 v[52:55], v[56:59], v[212:215], v[52:55]
  s_xor_b32 s94, s23, 491520
  buffer_load_dwordx4 v[136:139], v9, s[48:51], s94 offen offset:0 nt
  v_mov_b32_dpp v4, v30 row_newbcast:14 row_mask:0xf bank_mask:0xf
  v_perm_b32 v56, v4, v4, v16
  v_perm_b32 v57, v4, v4, v17
  v_perm_b32 v58, v4, v4, v18
  v_perm_b32 v59, v4, v4, v19
  s_waitcnt vmcnt(11)
  v_mfma_f32_16x16x32_bf16 v[52:55], v[60:63], v[216:219], v[52:55]
  buffer_load_dwordx4 v[140:143], v9, s[48:51], s94 offen offset:1024 nt
  v_mov_b32_dpp v5, v30 row_newbcast:15 row_mask:0xf bank_mask:0xf
  v_perm_b32 v60, v5, v5, v16
  v_perm_b32 v61, v5, v5, v17
  v_perm_b32 v62, v5, v5, v18
  v_perm_b32 v63, v5, v5, v19
  s_waitcnt vmcnt(11)
  v_mfma_f32_16x16x32_bf16 v[52:55], v[56:59], v[220:223], v[52:55]
  buffer_load_dwordx4 v[144:147], v9, s[48:51], s94 offen offset:2048 nt
  v_mov_b32_dpp v4, v31 row_newbcast:0 row_mask:0xf bank_mask:0xf
  v_perm_b32 v56, v4, v4, v16
  v_perm_b32 v57, v4, v4, v17
  v_perm_b32 v58, v4, v4, v18
  v_perm_b32 v59, v4, v4, v19
  s_waitcnt vmcnt(11)
  v_mfma_f32_16x16x32_bf16 v[52:55], v[60:63], v[224:227], v[52:55]
  buffer_load_dwordx4 v[148:151], v9, s[48:51], s94 offen offset:3072 nt
  v_mov_b32_dpp v5, v31 row_newbcast:1 row_mask:0xf bank_mask:0xf
  v_perm_b32 v60, v5, v5, v16
  v_perm_b32 v61, v5, v5, v17
  v_perm_b32 v62, v5, v5, v18
  v_perm_b32 v63, v5, v5, v19
  s_waitcnt vmcnt(11)
  v_mfma_f32_16x16x32_bf16 v[52:55], v[56:59], v[228:231], v[52:55]
  s_xor_b32 s94, s23, 507904
  buffer_load_dwordx4 v[152:155], v9, s[48:51], s94 offen offset:0 nt
  v_mov_b32_dpp v4, v31 row_newbcast:2 row_mask:0xf bank_mask:0xf
  v_perm_b32 v56, v4, v4, v16
  v_perm_b32 v57, v4, v4, v17
  v_perm_b32 v58, v4, v4, v18
  v_perm_b32 v59, v4, v4, v19
  s_waitcnt vmcnt(11)
  v_mfma_f32_16x16x32_bf16 v[52:55], v[60:63], v[232:235], v[52:55]
  buffer_load_dwordx4 v[156:159], v9, s[48:51], s94 offen offset:1024 nt
  v_mov_b32_dpp v5, v31 row_newbcast:3 row_mask:0xf bank_mask:0xf
  v_perm_b32 v60, v5, v5, v16
  v_perm_b32 v61, v5, v5, v17
  v_perm_b32 v62, v5, v5, v18
  v_perm_b32 v63, v5, v5, v19
  s_waitcnt vmcnt(11)
  v_mfma_f32_16x16x32_bf16 v[52:55], v[56:59], v[236:239], v[52:55]
  buffer_load_dwordx4 v[160:163], v9, s[48:51], s94 offen offset:2048 nt
  v_mov_b32_dpp v4, v31 row_newbcast:4 row_mask:0xf bank_mask:0xf
  v_perm_b32 v56, v4, v4, v16
  v_perm_b32 v57, v4, v4, v17
  v_perm_b32 v58, v4, v4, v18
  v_perm_b32 v59, v4, v4, v19
  s_waitcnt vmcnt(11)
  v_mfma_f32_16x16x32_bf16 v[52:55], v[60:63], v[240:243], v[52:55]
  buffer_load_dwordx4 v[164:167], v9, s[48:51], s94 offen offset:3072 nt
  v_mov_b32_dpp v5, v31 row_newbcast:5 row_mask:0xf bank_mask:0xf
  v_perm_b32 v60, v5, v5, v16
  v_perm_b32 v61, v5, v5, v17
  v_perm_b32 v62, v5, v5, v18
  v_perm_b32 v63, v5, v5, v19
  s_waitcnt vmcnt(11)
  v_mfma_f32_16x16x32_bf16 v[52:55], v[56:59], v[244:247], v[52:55]
  v_mov_b32_dpp v4, v31 row_newbcast:6 row_mask:0xf bank_mask:0xf
  v_perm_b32 v56, v4, v4, v16
  v_perm_b32 v57, v4, v4, v17
  v_perm_b32 v58, v4, v4, v18
  v_perm_b32 v59, v4, v4, v19
  s_waitcnt vmcnt(10)
  v_mfma_f32_16x16x32_bf16 v[52:55], v[60:63], v[248:251], v[52:55]
  v_mov_b32_dpp v5, v31 row_newbcast:7 row_mask:0xf bank_mask:0xf
  v_perm_b32 v60, v5, v5, v16
  v_perm_b32 v61, v5, v5, v17
  v_perm_b32 v62, v5, v5, v18
  v_perm_b32 v63, v5, v5, v19
  s_waitcnt vmcnt(9)
  v_mfma_f32_16x16x32_bf16 v[52:55], v[56:59], v[252:255], v[52:55]
  v_mov_b32_dpp v4, v31 row_newbcast:8 row_mask:0xf bank_mask:0xf
  v_perm_b32 v56, v4, v4, v16
  v_perm_b32 v57, v4, v4, v17
  v_perm_b32 v58, v4, v4, v18
  v_perm_b32 v59, v4, v4, v19
  s_waitcnt vmcnt(8)
  v_mfma_f32_16x16x32_bf16 v[52:55], v[60:63], v[132:135], v[52:55]
  v_mov_b32_dpp v5, v31 row_newbcast:9 row_mask:0xf bank_mask:0xf
  v_perm_b32 v60, v5, v5, v16
  v_perm_b32 v61, v5, v5, v17
  v_perm_b32 v62, v5, v5, v18
  v_perm_b32 v63, v5, v5, v19
  s_waitcnt vmcnt(7)
  v_mfma_f32_16x16x32_bf16 v[52:55], v[56:59], v[136:139], v[52:55]
  v_mov_b32_dpp v4, v31 row_newbcast:10 row_mask:0xf bank_mask:0xf
  v_perm_b32 v56, v4, v4, v16
  v_perm_b32 v57, v4, v4, v17
  v_perm_b32 v58, v4, v4, v18
  v_perm_b32 v59, v4, v4, v19
  s_waitcnt vmcnt(6)
  v_mfma_f32_16x16x32_bf16 v[52:55], v[60:63], v[140:143], v[52:55]
  v_mov_b32_dpp v5, v31 row_newbcast:11 row_mask:0xf bank_mask:0xf
  v_perm_b32 v60, v5, v5, v16
  v_perm_b32 v61, v5, v5, v17
  v_perm_b32 v62, v5, v5, v18
  v_perm_b32 v63, v5, v5, v19
  s_waitcnt vmcnt(5)
  v_mfma_f32_16x16x32_bf16 v[52:55], v[56:59], v[144:147], v[52:55]
  v_mov_b32_dpp v4, v31 row_newbcast:12 row_mask:0xf bank_mask:0xf
  v_perm_b32 v56, v4, v4, v16
  v_perm_b32 v57, v4, v4, v17
  v_perm_b32 v58, v4, v4, v18
  v_perm_b32 v59, v4, v4, v19
  s_waitcnt vmcnt(4)
  v_mfma_f32_16x16x32_bf16 v[52:55], v[60:63], v[148:151], v[52:55]
  v_mov_b32_dpp v5, v31 row_newbcast:13 row_mask:0xf bank_mask:0xf
  v_perm_b32 v60, v5, v5, v16
  v_perm_b32 v61, v5, v5, v17
  v_perm_b32 v62, v5, v5, v18
  v_perm_b32 v63, v5, v5, v19
  s_waitcnt vmcnt(3)
  v_mfma_f32_16x16x32_bf16 v[52:55], v[56:59], v[152:155], v[52:55]
  v_mov_b32_dpp v4, v31 row_newbcast:14 row_mask:0xf bank_mask:0xf
  v_perm_b32 v56, v4, v4, v16
  v_perm_b32 v57, v4, v4, v17
  v_perm_b32 v58, v4, v4, v18
  v_perm_b32 v59, v4, v4, v19
  s_waitcnt vmcnt(2)
  v_mfma_f32_16x16x32_bf16 v[52:55], v[60:63], v[156:159], v[52:55]
  v_mov_b32_dpp v5, v31 row_newbcast:15 row_mask:0xf bank_mask:0xf
  v_perm_b32 v60, v5, v5, v16
  v_perm_b32 v61, v5, v5, v17
  v_perm_b32 v62, v5, v5, v18
  v_perm_b32 v63, v5, v5, v19
  s_waitcnt vmcnt(1)
  v_mfma_f32_16x16x32_bf16 v[52:55], v[56:59], v[160:163], v[52:55]
  s_waitcnt vmcnt(0)
  v_mfma_f32_16x16x32_bf16 v[52:55], v[60:63], v[164:167], v[52:55]
  s_nop 7
  v_mul_f32 v52, v52, v83
  v_mul_f32 v53, v53, v83
  v_mul_f32 v54, v54, v83
  v_mul_f32 v55, v55, v83
  ds_write_b128 v11, v[52:55] offset:0
  s_waitcnt lgkmcnt(0)
  s_barrier
  ds_read_b128 v[64:67], v12 offset:0
  s_waitcnt lgkmcnt(0)
  v_add_f32_dpp v64, v64, v64 quad_perm:[1,0,3,2] row_mask:0xf bank_mask:0xf
  v_add_f32_dpp v65, v65, v65 quad_perm:[1,0,3,2] row_mask:0xf bank_mask:0xf
  v_add_f32_dpp v66, v66, v66 quad_perm:[1,0,3,2] row_mask:0xf bank_mask:0xf
  v_add_f32_dpp v67, v67, v67 quad_perm:[1,0,3,2] row_mask:0xf bank_mask:0xf
  v_add_f32_dpp v64, v64, v64 quad_perm:[2,3,0,1] row_mask:0xf bank_mask:0xf
  v_add_f32_dpp v65, v65, v65 quad_perm:[2,3,0,1] row_mask:0xf bank_mask:0xf
  v_add_f32_dpp v66, v66, v66 quad_perm:[2,3,0,1] row_mask:0xf bank_mask:0xf
  v_add_f32_dpp v67, v67, v67 quad_perm:[2,3,0,1] row_mask:0xf bank_mask:0xf
  v_add_f32_dpp v64, v64, v64 row_half_mirror row_mask:0xf bank_mask:0xf
  v_add_f32_dpp v65, v65, v65 row_half_mirror row_mask:0xf bank_mask:0xf
  v_add_f32_dpp v66, v66, v66 row_half_mirror row_mask:0xf bank_mask:0xf
  v_add_f32_dpp v67, v67, v67 row_half_mirror row_mask:0xf bank_mask:0xf
  v_cvt_pk_bf16_f32 v68, v64, v64
  v_cvt_pk_bf16_f32 v69, v65, v65
  v_cvt_pk_bf16_f32 v70, v66, v66
  v_cvt_pk_bf16_f32 v71, v67, v67
  v_lshlrev_b32 v68, 16, v68
  v_lshlrev_b32 v69, 16, v69
  v_lshlrev_b32 v70, 16, v70
  v_lshlrev_b32 v71, 16, v71
  v_sub_f32 v68, v64, v68
  v_sub_f32 v69, v65, v69
  v_sub_f32 v70, v66, v70
  v_sub_f32 v71, v67, v71
  v_cvt_pk_bf16_f32 v64, v64, v68
  v_cvt_pk_bf16_f32 v65, v65, v69
  v_cvt_pk_bf16_f32 v66, v66, v70
  v_cvt_pk_bf16_f32 v67, v67, v71
  v_mov_b32_dpp v4, v64 row_newbcast:0 row_mask:0xf bank_mask:0xf
  v_perm_b32 v56, v4, v4, v16
  v_perm_b32 v57, v4, v4, v17
  v_perm_b32 v58, v4, v4, v18
  v_perm_b32 v59, v4, v4, v19
  s_nop 1
  v_mfma_f32_16x16x32_bf16 v[32:35], v[56:59], a[0:3], v[32:35]
  v_mov_b32_dpp v5, v65 row_newbcast:0 row_mask:0xf bank_mask:0xf
  v_perm_b32 v60, v5, v5, v16
  v_perm_b32 v61, v5, v5, v17
  v_perm_b32 v62, v5, v5, v18
  v_perm_b32 v63, v5, v5, v19
  v_mfma_f32_16x16x32_bf16 v[36:39], v[56:59], a[4:7], v[36:39]
  v_mfma_f32_16x16x32_bf16 v[40:43], v[56:59], a[8:11], v[40:43]
  v_mfma_f32_16x16x32_bf16 v[44:47], v[56:59], a[12:15], v[44:47]
  v_mfma_f32_16x16x32_bf16 v[48:51], v[56:59], a[16:19], v[48:51]
  v_mfma_f32_16x16x32_bf16 v[32:35], v[60:63], a[20:23], v[32:35]
  v_mov_b32_dpp v4, v66 row_newbcast:0 row_mask:0xf bank_mask:0xf
  v_perm_b32 v56, v4, v4, v16
  v_perm_b32 v57, v4, v4, v17
  v_perm_b32 v58, v4, v4, v18
  v_perm_b32 v59, v4, v4, v19
  v_mfma_f32_16x16x32_bf16 v[36:39], v[60:63], a[24:27], v[36:39]
  v_mfma_f32_16x16x32_bf16 v[40:43], v[60:63], a[28:31], v[40:43]
  v_mfma_f32_16x16x32_bf16 v[44:47], v[60:63], a[32:35], v[44:47]
  v_mfma_f32_16x16x32_bf16 v[48:51], v[60:63], a[36:39], v[48:51]
  v_mfma_f32_16x16x32_bf16 v[32:35], v[56:59], a[40:43], v[32:35]
  v_mov_b32_dpp v5, v67 row_newbcast:0 row_mask:0xf bank_mask:0xf
  v_perm_b32 v60, v5, v5, v16
  v_perm_b32 v61, v5, v5, v17
  v_perm_b32 v62, v5, v5, v18
  v_perm_b32 v63, v5, v5, v19
  v_mfma_f32_16x16x32_bf16 v[36:39], v[56:59], a[44:47], v[36:39]
  v_mfma_f32_16x16x32_bf16 v[40:43], v[56:59], a[48:51], v[40:43]
  v_mfma_f32_16x16x32_bf16 v[44:47], v[56:59], a[52:55], v[44:47]
  v_mfma_f32_16x16x32_bf16 v[48:51], v[56:59], a[56:59], v[48:51]
  v_mfma_f32_16x16x32_bf16 v[32:35], v[60:63], a[60:63], v[32:35]
  v_mov_b32_dpp v4, v64 row_newbcast:8 row_mask:0xf bank_mask:0xf
  v_perm_b32 v56, v4, v4, v16
  v_perm_b32 v57, v4, v4, v17
  v_perm_b32 v58, v4, v4, v18
  v_perm_b32 v59, v4, v4, v19
  v_mfma_f32_16x16x32_bf16 v[36:39], v[60:63], a[64:67], v[36:39]
  v_mfma_f32_16x16x32_bf16 v[40:43], v[60:63], a[68:71], v[40:43]
  v_mfma_f32_16x16x32_bf16 v[44:47], v[60:63], a[72:75], v[44:47]
  v_mfma_f32_16x16x32_bf16 v[48:51], v[60:63], a[76:79], v[48:51]
  v_mfma_f32_16x16x32_bf16 v[32:35], v[56:59], a[80:83], v[32:35]
  v_mov_b32_dpp v5, v65 row_newbcast:8 row_mask:0xf bank_mask:0xf
  v_perm_b32 v60, v5, v5, v16
  v_perm_b32 v61, v5, v5, v17
  v_perm_b32 v62, v5, v5, v18
  v_perm_b32 v63, v5, v5, v19
  v_mfma_f32_16x16x32_bf16 v[36:39], v[56:59], a[84:87], v[36:39]
  v_mfma_f32_16x16x32_bf16 v[40:43], v[56:59], a[88:91], v[40:43]
  v_mfma_f32_16x16x32_bf16 v[44:47], v[56:59], a[92:95], v[44:47]
  v_mfma_f32_16x16x32_bf16 v[48:51], v[56:59], a[96:99], v[48:51]
  v_mfma_f32_16x16x32_bf16 v[32:35], v[60:63], a[100:103], v[32:35]
  v_mov_b32_dpp v4, v66 row_newbcast:8 row_mask:0xf bank_mask:0xf
  v_perm_b32 v56, v4, v4, v16
  v_perm_b32 v57, v4, v4, v17
  v_perm_b32 v58, v4, v4, v18
  v_perm_b32 v59, v4, v4, v19
  v_mfma_f32_16x16x32_bf16 v[36:39], v[60:63], a[104:107], v[36:39]
  v_mfma_f32_16x16x32_bf16 v[40:43], v[60:63], a[108:111], v[40:43]
  v_mfma_f32_16x16x32_bf16 v[44:47], v[60:63], a[112:115], v[44:47]
  v_mfma_f32_16x16x32_bf16 v[48:51], v[60:63], a[116:119], v[48:51]
  v_mfma_f32_16x16x32_bf16 v[32:35], v[56:59], a[120:123], v[32:35]
  v_mov_b32_dpp v5, v67 row_newbcast:8 row_mask:0xf bank_mask:0xf
  v_perm_b32 v60, v5, v5, v16
  v_perm_b32 v61, v5, v5, v17
  v_perm_b32 v62, v5, v5, v18
  v_perm_b32 v63, v5, v5, v19
  v_mfma_f32_16x16x32_bf16 v[36:39], v[56:59], a[124:127], v[36:39]
  v_mfma_f32_16x16x32_bf16 v[40:43], v[56:59], a[128:131], v[40:43]
  v_mfma_f32_16x16x32_bf16 v[44:47], v[56:59], a[132:135], v[44:47]
  v_mfma_f32_16x16x32_bf16 v[48:51], v[56:59], a[136:139], v[48:51]
  v_mfma_f32_16x16x32_bf16 v[32:35], v[60:63], a[140:143], v[32:35]
  v_mfma_f32_16x16x32_bf16 v[36:39], v[60:63], a[144:147], v[36:39]
  v_mfma_f32_16x16x32_bf16 v[40:43], v[60:63], a[148:151], v[40:43]
  v_mfma_f32_16x16x32_bf16 v[44:47], v[60:63], a[152:155], v[44:47]
  v_mfma_f32_16x16x32_bf16 v[48:51], v[60:63], a[156:159], v[48:51]
  s_nop 3
  v_permlane32_swap_b32 v32, v34
  v_permlane32_swap_b32 v33, v35
  v_pk_add_f32 v[32:33], v[32:33], v[34:35]
  ds_write_b64 v13, v[32:33] offset:5376
  v_permlane32_swap_b32 v36, v38
  v_permlane32_swap_b32 v37, v39
  v_pk_add_f32 v[36:37], v[36:37], v[38:39]
  ds_write_b64 v13, v[36:37] offset:5888
  v_permlane32_swap_b32 v40, v42
  v_permlane32_swap_b32 v41, v43
  v_pk_add_f32 v[40:41], v[40:41], v[42:43]
  ds_write_b64 v13, v[40:41] offset:6400
  v_permlane32_swap_b32 v44, v46
  v_permlane32_swap_b32 v45, v47
  v_pk_add_f32 v[44:45], v[44:45], v[46:47]
  ds_write_b64 v13, v[44:45] offset:6912
  v_permlane32_swap_b32 v48, v50
  v_permlane32_swap_b32 v49, v51
  v_pk_add_f32 v[48:49], v[48:49], v[50:51]
  ds_write_b64 v13, v[48:49] offset:7424
  s_waitcnt lgkmcnt(0)
  s_barrier
  ds_read_b128 v[64:67], v14 offset:5376
  ds_read_b128 v[68:71], v14 offset:7936
  ds_read_b128 v[72:75], v14 offset:10496
  ds_read_b128 v[76:79], v14 offset:13056
  s_mov_b32 exec_hi, 0xff
  s_waitcnt lgkmcnt(2)
  v_pk_add_f32 v[64:65], v[64:65], v[68:69]
  v_pk_add_f32 v[66:67], v[66:67], v[70:71]
  s_waitcnt lgkmcnt(0)
  v_pk_add_f32 v[72:73], v[72:73], v[76:77]
  v_pk_add_f32 v[74:75], v[74:75], v[78:79]
  v_pk_add_f32 v[64:65], v[64:65], v[72:73]
  v_pk_add_f32 v[66:67], v[66:67], v[74:75]
  v_min_u32 v64, -2, v64
  v_min_u32 v65, -2, v65
  v_min_u32 v66, -2, v66
  v_min_u32 v67, -2, v67
  buffer_store_dwordx4 v[64:67], v15, s[76:79], 0 offen sc1
  s_mov_b64 exec, -1
  s_cmp_lt_u32 s4, 27
  s_cbranch_scc1 L_done
  s_mov_b32 s96, 0
L_fin_loop:
  buffer_load_dwordx4 v[64:67], v96, s[76:79], 0 offen sc1
  buffer_load_dwordx4 v[68:71], v97, s[76:79], 0 offen sc1
  buffer_load_dwordx4 v[72:75], v98, s[76:79], 0 offen sc1
  buffer_load_dwordx4 v[76:79], v99, s[76:79], 0 offen sc1
  s_add_u32 s96, s96, 1
  s_waitcnt vmcnt(2)
  v_max3_u32 v5, v64, v65, v66
  v_max3_u32 v6, v67, v68, v69
  v_max3_u32 v5, v5, v70, v71
  v_pk_add_f32 v[64:65], v[64:65], v[68:69]
  v_pk_add_f32 v[66:67], v[66:67], v[70:71]
  s_waitcnt vmcnt(0)
  v_max3_u32 v6, v6, v72, v73
  v_max3_u32 v5, v5, v74, v75
  v_max3_u32 v6, v6, v76, v77
  v_max3_u32 v5, v5, v78, v79
  v_max_u32 v5, v5, v6
  v_cmp_eq_u32 vcc, -1, v5
  v_pk_add_f32 v[72:73], v[72:73], v[76:77]
  v_pk_add_f32 v[74:75], v[74:75], v[78:79]
  s_cmp_eq_u64 vcc, 0
  s_cbranch_scc1 L_fin_go
  s_cmp_lt_u32 s96, 20000
  s_cbranch_scc1 L_fin_loop
L_fin_go:
  s_cmp_eq_u32 0, 1
L_fin_ok:
  v_pk_add_f32 v[64:65], v[64:65], v[72:73]
  v_pk_add_f32 v[66:67], v[66:67], v[74:75]
  s_nop 0
  v_add_f32_dpp v64, v64, v64 row_ror:8 row_mask:0xf bank_mask:0xf
  v_add_f32_dpp v65, v65, v65 row_ror:8 row_mask:0xf bank_mask:0xf
  v_add_f32_dpp v66, v66, v66 row_ror:8 row_mask:0xf bank_mask:0xf
  v_add_f32_dpp v67, v67, v67 row_ror:8 row_mask:0xf bank_mask:0xf
  v_permlane16_swap_b32 v64, v65
  s_nop 0
  v_permlane16_swap_b32 v66, v67
  v_add_f32 v64, v64, v65
  v_add_f32 v66, v66, v67
  s_nop 1
  v_permlane32_swap_b32 v64, v66
  v_add_f32 v64, v64, v66
  ds_write_b32 v100, v64 offset:15616
  s_waitcnt lgkmcnt(0)
  s_barrier
  ds_read_b64 v[64:65], v101 offset:15616
  ds_read_b64 v[66:67], v101 offset:15744
  ds_read_b64 v[68:69], v101 offset:15872
  ds_read_b64 v[70:71], v101 offset:16000
  s_mov_b64 exec, s[26:27]
  s_waitcnt lgkmcnt(0)
  v_pk_add_f32 v[64:65], v[64:65], v[66:67]
  v_pk_add_f32 v[68:69], v[68:69], v[70:71]
  v_pk_add_f32 v[64:65], v[64:65], v[68:69]
  v_cvt_pk_bf16_f32 v64, v64, v65
  buffer_store_dword v64, v102, s[84:87], 0 offen
  s_mov_b64 exec, -1
L_done:
L_end:
  s_endpgm
L_slow_cnt:
  s_mov_b32 s96, 0
L_slow_loop_cnt:
  s_sleep 8
  buffer_load_dword v94, v86, s[80:83], 0 offen sc1
  s_add_u32 s96, s96, 1
  s_waitcnt vmcnt(0)
  v_cmp_gt_u32 vcc, 4, v94
  s_nop 0
  s_cmp_eq_u64 vcc, 0
  s_nop 7
  s_nop 3
  s_cbranch_scc1 L_ok_cnt
  s_cmp_lt_u32 s96, 20000
  s_cbranch_scc1 L_slow_loop_cnt
  s_branch L_ok_cnt
L_slow_p:
  s_mov_b32 s96, 0
L_slow_loop_p:
  s_sleep 8
  buffer_load_dwordx4 v[72:75], v8, s[76:79], 0 offen sc1
  buffer_load_dwordx4 v[76:79], v8, s[76:79], s30 offen sc1
  buffer_load_dwordx2 v[90:91], v85, s[76:79], 0 offen sc1
  s_add_u32 s96, s96, 1
  s_waitcnt vmcnt(0)
  v_max3_u32 v92, v72, v73, v74
  v_max3_u32 v93, v75, v76, v77
  v_max3_u32 v92, v92, v78, v79
  v_max3_u32 v93, v93, v90, v91
  v_max_u32 v92, v92, v93
  v_cmp_eq_u32 vcc, -1, v92
  s_nop 0
  s_cmp_eq_u64 vcc, 0
  s_nop 7
  s_nop 3
  s_cbranch_scc1 L_ok_p
  s_cmp_lt_u32 s96, 20000
  s_cbranch_scc1 L_slow_loop_p
  s_branch L_ok_p
.section .rodata,"a"
.p2align 6
.amdhsa_kernel gated_mix__gqa_block_cached__geglu_ffn__decode_kernel
  .amdhsa_next_free_vgpr 456
  .amdhsa_next_free_sgpr 102
  .amdhsa_accum_offset 256
  .amdhsa_group_segment_fixed_size 0
  .amdhsa_kernarg_size 104
  .amdhsa_user_sgpr_count 2
  .amdhsa_user_sgpr_kernarg_segment_ptr 1
  .amdhsa_system_sgpr_workgroup_id_x 1
.end_amdhsa_kernel
```
